```python
import torch

def _softmax(x, axis=-1):
    return torch.softmax(x, dim=axis)

def _gelu(x):
    return torch.nn.functional.gelu(x, approximate='tanh')

def _silu(x):
    return torch.nn.functional.silu(x)

def _sigmoid(x):
    return torch.sigmoid(x)

def _layernorm(x, axis=-1, eps=1e-05):
    m = x.mean(dim=axis, keepdim=True)
    v = x.var(dim=axis, keepdim=True, unbiased=False)
    return (x - m) / torch.sqrt(v + eps)

def _scatter_add(tgt, idx, src, axis=0):
    return tgt.clone().index_add_(axis, idx, src)

def _segment_sum(src, seg, n):
    out = torch.zeros((n,) + src.shape[1:], dtype=src.dtype)
    return out.index_add_(0, seg, src)

def _pad(x, pw):
    flat = tuple((v for pair in reversed(pw) for v in pair))
    return torch.nn.functional.pad(x, flat)
kernel_name = 'adaLN_cond__gqa_block_cached__swiglu_ffn__decode'

def setup_inputs():

    _w = lambda a: (lambda t: t.to(torch.bfloat16) if t.is_floating_point() else t)(torch.as_tensor(a))

    def _A_setup():
        B, Sq, D = (1, 1, 1024)
        Hq, Hkv, Sk, Dh = (32, 4, 65536, 128)
        assert Hq % Hkv == 0, (Hq, Hkv)
        return {'x': _w((lambda *s: torch.randn(*s, dtype=torch.bfloat16) * 0.05)(B, Sq, D)), 'k_cache': _w((lambda *s: torch.randn(*s, dtype=torch.bfloat16) * 3.2)(B, Hkv, Sk, Dh)), 'v_cache': _w((lambda *s: torch.randn(*s, dtype=torch.bfloat16) * 0.4)(B, Hkv, Sk, Dh)), 'wq': _w((lambda *s: torch.randn(*s, dtype=torch.bfloat16) * 3.2)(D, Hq * Dh) * D ** (-0.5)), 'wo': _w((lambda *s: torch.randn(*s, dtype=torch.bfloat16) * 0.4)(Hq * Dh, D) * (Hq * Dh) ** (-0.5))}
    _A_in = _A_setup()

    def _B_setup():
        B, S, D, F = (1, 1, 1024, 3584)
        return {'x': _w((lambda *s: torch.randn(*s, dtype=torch.bfloat16) * 0.05)(B, S, D)), 'w_gate': _w((lambda *s: torch.randn(*s, dtype=torch.bfloat16) * 0.05)(D, F)), 'w_up': _w((lambda *s: torch.randn(*s, dtype=torch.bfloat16) * 0.05)(D, F)), 'w_down': _w((lambda *s: torch.randn(*s, dtype=torch.bfloat16) * 0.05)(F, D))}
    _B_in = _B_setup()
    return {'A_x': _A_in['x'], 'A_k_cache': _A_in['k_cache'], 'A_v_cache': _A_in['v_cache'], 'A_wq': _A_in['wq'], 'A_wo': _A_in['wo'], 'B_x': _B_in['x'], 'B_w_gate': _B_in['w_gate'], 'B_w_up': _B_in['w_up'], 'B_w_down': _B_in['w_down'], 'c': _w((lambda *s: torch.randn(*s, dtype=torch.bfloat16) * 0.4)(1, 1024) * 8.0), 'w_mod': _w((lambda *s: torch.randn(*s, dtype=torch.bfloat16) * 0.4)(1024, 6 * 1024) * 1024 ** (-0.5) * 8.0)}

def reference(A_x, A_k_cache, A_v_cache, A_wq, A_wo, B_x, B_w_gate, B_w_up, B_w_down, c, w_mod):

    def _A_ref(x, k_cache, v_cache, wq, wo):
        B, Sq, D = x.shape
        Hq, Dh = (32, 128)
        Hkv = k_cache.shape[1]
        rep = Hq // Hkv
        q = (lambda x, *d: x.permute(*d))((x @ wq).reshape(B, Sq, Hq, Dh), 0, 2, 1, 3)
        k = (lambda x, n, axis: torch.repeat_interleave(x, n, dim=axis))(k_cache, rep, axis=1)
        v = (lambda x, n, axis: torch.repeat_interleave(x, n, dim=axis))(v_cache, rep, axis=1)
        scores = torch.einsum('bhqd,bhkd->bhqk', q, k) * Dh ** (-0.5)
        p = _softmax(scores, axis=-1)
        o = torch.einsum('bhqk,bhkd->bhqd', p, v)
        return (lambda x, *d: x.permute(*d))(o, 0, 2, 1, 3).reshape(B, Sq, Hq * Dh) @ wo

    def _B_ref(x, w_gate, w_up, w_down):
        g = _silu(x @ w_gate)
        u = x @ w_up
        return g * u @ w_down
    x = A_x
    mod = (_silu(c) @ w_mod).reshape(c.shape[0], 6, 1, -1)
    sa, ca, ga, sb, cb, gb = (mod[:, 0].clone(), mod[:, 1].clone(), mod[:, 2].clone(), mod[:, 3].clone(), mod[:, 4].clone(), mod[:, 5].clone())
    h = _layernorm(x, axis=-1) * (1 + ca) + sa
    x = x + ga * _A_ref(h, A_k_cache, A_v_cache, A_wq, A_wo)
    h = _layernorm(x, axis=-1) * (1 + cb) + sb
    x = x + gb * _B_ref(h, B_w_gate, B_w_up, B_w_down)
    return x
```

```asm
; @launch grid=(256,1,1) block=(768,1,1) lds=47104
.amdgcn_target "amdgcn-amd-amdhsa--gfx950"
.text
.globl adaLN_cond__gqa_block_cached__swiglu_ffn__decode_kernel
.p2align 8
.type adaLN_cond__gqa_block_cached__swiglu_ffn__decode_kernel,@function
adaLN_cond__gqa_block_cached__swiglu_ffn__decode_kernel:
    s_cmp_ge_u32 s2, 256
    s_cbranch_scc1 L_end
    s_load_dwordx2 s[12:13], s[0:1], 104
    s_getpc_b64 s[8:9]
L_pc:
    s_mov_b32 s10, L_codeend-L_pc
    s_mov_b32 s11, 0x20000
    v_lshlrev_b32 v2, 7, v0
    v_lshrrev_b32 v1, 6, v0
    buffer_load_dword v167, v2, s[8:11], 0 offen
    v_readfirstlane_b32 s3, v1
    v_and_b32 v0, 63, v0
    s_mov_b32 s32, 0x05040100
    s_mov_b32 s33, 0x07060302
    s_mov_b32 s14, 0x10000000
    s_mov_b32 s15, 0x20000
    s_cmp_ge_u32 s3, 4
    s_cbranch_scc1 L_worker
    s_load_dwordx2 s[16:17], s[0:1], 80
    s_load_dwordx2 s[24:25], s[0:1], 72
    s_load_dwordx2 s[20:21], s[0:1], 24
    s_load_dwordx2 s[28:29], s[0:1], 0
    s_load_dwordx2 s[4:5], s[0:1], 88
    s_setprio 3
    s_mov_b32 s18, 0xc00000
    s_mov_b32 s19, 0x20000
    s_mov_b32 s26, 0x800
    s_mov_b32 s27, 0x20000
    v_lshrrev_b32 v1, 3, v0
    v_mul_u32_u24 v1, 0xc000, v1
    v_and_b32 v3, 7, v0
    v_lshl_add_u32 v1, v3, 4, v1
    v_lshrrev_b32 v2, 3, v0
    v_lshlrev_b32 v2, 3, v2
    s_lshr_b32 s35, s2, 5
    s_lshl_b32 s35, s35, 2
    s_add_u32 s35, s35, s3
    s_lshl_b32 s35, s35, 5
    s_mul_i32 s36, s35, 12288
    s_and_b32 s37, s2, 31
    s_lshl_b32 s37, s37, 7
    s_add_u32 s36, s36, s37
    s_lshl_b32 s35, s35, 1
    s_mov_b32 s22, 0x800000
    s_mov_b32 s23, 0x20000
    s_mov_b32 s30, 0x800
    s_mov_b32 s31, 0x20000
    s_mov_b32 s6, 0x800
    s_mov_b32 s7, 0x20000
    v_lshlrev_b32 v4, 4, v0
    v_mov_b32 v12, -1
    v_mov_b32 v13, -1
    v_mov_b32 v14, -1
    v_mov_b32 v15, -1
    s_and_b32 s49, s2, 63
    s_lshl_b32 s46, s49, 2
    s_lshr_b32 s47, s2, 6
    s_add_u32 s46, s46, s47
    s_lshl_b32 s46, s46, 8
    s_lshl_b32 s48, s47, 2
    s_add_u32 s48, s48, s3
    s_lshl_b32 s48, s48, 6
    v_lshrrev_b32 v6, 3, v0
    v_mul_u32_u24 v6, 0x8000, v6
    v_and_b32 v3, 7, v0
    v_lshl_add_u32 v6, v3, 4, v6
    s_waitcnt lgkmcnt(0)
    s_load_dword s34, s[12:13], 0x0
    buffer_load_dwordx2 v[8:9], v2, s[24:27], s35 offen
    s_add_u32 s37, s36, 0
    buffer_load_dwordx4 v[40:43], v1, s[16:19], s37 offen nt
    s_add_u32 s37, s36, 12288
    buffer_load_dwordx4 v[44:47], v1, s[16:19], s37 offen nt
    s_add_u32 s37, s36, 24576
    buffer_load_dwordx4 v[48:51], v1, s[16:19], s37 offen nt
    s_add_u32 s37, s36, 36864
    buffer_load_dwordx4 v[52:55], v1, s[16:19], s37 offen nt
    s_lshl_b32 s37, s2, 9
    s_and_b32 s38, s3, 1
    s_lshl_b32 s38, s38, 8
    s_add_u32 s37, s37, s38
    s_add_u32 s37, s37, 0xa0000
    s_add_u32 s38, s46, 0x30000
    s_add_u32 s39, s46, 0x40000
    s_cmp_eq_u32 s3, 1
    s_cselect_b32 s37, s38, s37
    s_cmp_eq_u32 s3, 2
    s_cselect_b32 s37, s39, s37
    s_mov_b64 exec, 0xffff
    buffer_store_dwordx4 v[12:15], v4, s[12:15], s37 offen sc1
    s_mov_b64 exec, -1
    s_mul_i32 s44, s3, 11
    s_add_u32 s44, s44, 9
    s_lshl_b32 s36, s48, 13
    s_lshl_b32 s45, s49, 7
    s_add_u32 s36, s36, s45
    s_add_u32 s37, s36, 0
    buffer_load_dwordx4 v[56:59], v6, s[20:23], s37 offen nt
    s_add_u32 s37, s36, 8192
    buffer_load_dwordx4 v[60:63], v6, s[20:23], s37 offen nt
    ds_write_b128 v4, v[12:15] offset:1024
    v_mov_b32 v7, 0
    v_mov_b32 v16, 0
    v_mov_b32 v17, 0
    v_mov_b32 v18, 0
    v_mov_b32 v19, 0
    ds_write_b128 v7, v[16:19] offset:0
    ds_write_b128 v7, v[16:19] offset:16
    ds_write_b128 v7, v[16:19] offset:32
    ds_write_b128 v7, v[16:19] offset:48
    s_waitcnt lgkmcnt(0)
    s_barrier
    s_branch L_comm2
L_worker:
    s_load_dwordx2 s[4:5], s[0:1], 8
    s_load_dwordx2 s[48:49], s[0:1], 16
    s_load_dwordx2 s[16:17], s[0:1], 32
    s_load_dwordx4 s[20:23], s[0:1], 48
    s_load_dwordx2 s[28:29], s[0:1], 64
    s_mov_b32 s6, 0x4000000
    s_mov_b32 s7, 0x20000
    s_sub_u32 s35, s3, 4
    s_bfe_u32 s36, s2, 0x20001
    s_lshl_b32 s36, s36, 24
    s_lshr_b32 s37, s2, 3
    s_lshl_b32 s37, s37, 1
    s_and_b32 s38, s2, 1
    s_add_u32 s37, s37, s38
    s_lshl_b32 s37, s37, 3
    s_add_u32 s37, s37, s35
    s_lshl_b32 s37, s37, 13
    s_add_u32 s36, s36, s37
    v_bfe_u32 v1, v0, 2, 2
    v_lshlrev_b32 v1, 8, v1
    v_bfe_u32 v2, v0, 1, 1
    v_lshl_add_u32 v1, v2, 10, v1
    v_lshrrev_b32 v2, 4, v0
    v_lshl_add_u32 v1, v2, 5, v1
    v_and_b32 v3, 1, v0
    v_lshl_add_u32 v1, v3, 4, v1
    s_mov_b32 s50, 0x4000000
    s_mov_b32 s51, 0x20000
    s_mov_b32 s18, 0x800000
    s_mov_b32 s19, 0x20000
    s_mov_b32 s30, 0x700000
    s_mov_b32 s31, 0x20000
    v_lshlrev_b32 v2, 4, v0
    v_mov_b32 v4, 0
    v_and_b32 v5, 7, v0
    v_lshlrev_b32 v5, 8, v5
    v_lshrrev_b32 v3, 3, v0
    v_lshl_add_u32 v5, v3, 4, v5
    s_waitcnt lgkmcnt(0)
    s_load_dword s34, s[12:13], 0x0
    s_waitcnt lgkmcnt(0)
    s_add_u32 s34, s34, 1
    s_add_u32 s8, s34, 0
    s_and_b32 s8, s8, 15
    s_add_u32 s9, s34, 5
    s_and_b32 s9, s9, 15
    s_barrier
    s_cmp_lg_u32 s3, 4
    s_cbranch_scc1 L_noprobe
    s_lshr_b32 s56, s2, 3
    s_lshl_b32 s56, s56, 14
    s_and_b32 s57, s2, 7
    s_lshl_b32 s57, s57, 10
    s_add_u32 s56, s56, s57
    s_add_u32 s56, s56, 0x100000
    s_mov_b32 s57, 32
    s_load_dword s38, s[12:13], s56 offset:0x0 glc
    s_load_dword s38, s[12:13], s56 offset:0x2000 glc
    s_load_dword s38, s[12:13], s56 offset:0x80 glc
    s_load_dword s38, s[12:13], s56 offset:0x2080 glc
    s_waitcnt lgkmcnt(0)
    s_mov_b32 s38, s34
    s_mov_b32 s39, 200
    s_load_dword s38, s[12:13], s56 offset:0x0 glc
L_pr_1:
    s_cmp_lg_u32 s38, s34
    s_cbranch_scc1 L_prx_2
    s_sub_u32 s39, s39, 1
    s_cbranch_scc0 L_pr_1
L_prx_2:
    s_waitcnt lgkmcnt(0)
    s_mov_b32 s38, s34
    s_mov_b32 s40, 200
    s_load_dword s38, s[12:13], s56 offset:0x2000 glc
L_pr_3:
    s_cmp_lg_u32 s38, s34
    s_cbranch_scc1 L_prx_4
    s_sub_u32 s40, s40, 1
    s_cbranch_scc0 L_pr_3
L_prx_4:
    s_waitcnt lgkmcnt(0)
    s_sub_i32 s39, s40, s39
    s_min_i32 s39, s39, 10
    s_max_i32 s39, s39, -10
    s_add_u32 s57, s57, s39
    s_mov_b32 s38, s34
    s_mov_b32 s40, 200
    s_load_dword s38, s[12:13], s56 offset:0x2080 glc
L_pr_5:
    s_cmp_lg_u32 s38, s34
    s_cbranch_scc1 L_prx_6
    s_sub_u32 s40, s40, 1
    s_cbranch_scc0 L_pr_5
L_prx_6:
    s_waitcnt lgkmcnt(0)
    s_mov_b32 s38, s34
    s_mov_b32 s39, 200
    s_load_dword s38, s[12:13], s56 offset:0x80 glc
L_pr_7:
    s_cmp_lg_u32 s38, s34
    s_cbranch_scc1 L_prx_8
    s_sub_u32 s39, s39, 1
    s_cbranch_scc0 L_pr_7
L_prx_8:
    s_waitcnt lgkmcnt(0)
    s_sub_i32 s39, s40, s39
    s_min_i32 s39, s39, 10
    s_max_i32 s39, s39, -10
    s_add_u32 s57, s57, s39
    s_getreg_b32 s38, hwreg(HW_REG_XCC_ID, 0, 4)
    s_lshl4_add_u32 s38, s34, s38
    s_lshl_b32 s38, s38, 6
    s_or_b32 s38, s38, s57
    v_mov_b32 v3, s38
    s_and_b32 s37, s2, 7
    s_lshl_b32 s37, s37, 5
    s_lshr_b32 s38, s2, 3
    s_add_u32 s37, s37, s38
    s_lshl_b32 s37, s37, 2
    s_add_u32 s37, s37, 0x9000
    s_mov_b64 exec, 1
    buffer_store_dword v3, v4, s[12:15], s37 offen sc1
    s_mov_b64 exec, -1
L_noprobe:
    s_barrier
    s_add_u32 s37, s36, 0x0
    buffer_load_dwordx4 v[40:43], v1, s[4:7], s37 offen offset:0 nt
    buffer_load_dwordx4 v[44:47], v1, s[4:7], s37 offen offset:128 nt
    buffer_load_dwordx4 v[48:51], v1, s[4:7], s37 offen offset:2048 nt
    s_waitcnt vmcnt(2)
    buffer_load_dwordx4 v[52:55], v1, s[4:7], s37 offen offset:2176 nt
    s_waitcnt vmcnt(2)
    s_add_u32 s37, s36, 0x1000
    buffer_load_dwordx4 v[56:59], v1, s[4:7], s37 offen offset:0 nt
    s_waitcnt vmcnt(2)
    buffer_load_dwordx4 v[60:63], v1, s[4:7], s37 offen offset:128 nt
    s_waitcnt vmcnt(2)
    buffer_load_dwordx4 v[64:67], v1, s[4:7], s37 offen offset:2048 nt
    s_waitcnt vmcnt(2)
    buffer_load_dwordx4 v[68:71], v1, s[4:7], s37 offen offset:2176 nt
    s_waitcnt vmcnt(2)
    s_add_u32 s37, s36, 0x400000
    buffer_load_dwordx4 v[72:75], v1, s[4:7], s37 offen offset:0 nt
    s_waitcnt vmcnt(2)
    buffer_load_dwordx4 v[76:79], v1, s[4:7], s37 offen offset:128 nt
    s_waitcnt vmcnt(2)
    buffer_load_dwordx4 v[80:83], v1, s[4:7], s37 offen offset:2048 nt
    s_waitcnt vmcnt(2)
    buffer_load_dwordx4 v[84:87], v1, s[4:7], s37 offen offset:2176 nt
    s_waitcnt vmcnt(2)
    s_add_u32 s37, s36, 0x401000
    buffer_load_dwordx4 v[88:91], v1, s[4:7], s37 offen offset:0 nt
    s_waitcnt vmcnt(2)
    buffer_load_dwordx4 v[92:95], v1, s[4:7], s37 offen offset:128 nt
    s_waitcnt vmcnt(2)
    buffer_load_dwordx4 v[96:99], v1, s[4:7], s37 offen offset:2048 nt
    s_waitcnt vmcnt(2)
    buffer_load_dwordx4 v[100:103], v1, s[4:7], s37 offen offset:2176 nt
    s_waitcnt vmcnt(2)
    s_add_u32 s37, s36, 0x800000
    buffer_load_dwordx4 v[104:107], v1, s[4:7], s37 offen offset:0 nt
    s_waitcnt vmcnt(2)
    buffer_load_dwordx4 v[108:111], v1, s[4:7], s37 offen offset:128 nt
    s_waitcnt vmcnt(2)
    buffer_load_dwordx4 v[112:115], v1, s[4:7], s37 offen offset:2048 nt
    s_waitcnt vmcnt(2)
    buffer_load_dwordx4 v[116:119], v1, s[4:7], s37 offen offset:2176 nt
    s_waitcnt vmcnt(2)
    s_add_u32 s37, s36, 0x801000
    buffer_load_dwordx4 v[120:123], v1, s[4:7], s37 offen offset:0 nt
    v_mov_b32 v8, 21
    s_mov_b64 exec, 1
    ds_add_rtn_u32 v9, v4, v8 offset:60
    s_mov_b64 exec, -1
    s_waitcnt vmcnt(2)
    buffer_load_dwordx4 v[124:127], v1, s[4:7], s37 offen offset:128 nt
    v_mov_b32 v8, 1
    s_mov_b64 exec, 1
    ds_add_rtn_u32 v9, v4, v8 offset:60
    s_mov_b64 exec, -1
    s_waitcnt vmcnt(2)
    buffer_load_dwordx4 v[128:131], v1, s[4:7], s37 offen offset:2048 nt
    v_mov_b32 v8, 1
    s_mov_b64 exec, 1
    ds_add_rtn_u32 v9, v4, v8 offset:60
    s_mov_b64 exec, -1
    s_waitcnt vmcnt(2)
    buffer_load_dwordx4 v[132:135], v1, s[4:7], s37 offen offset:2176 nt
    v_mov_b32 v8, 1
    s_mov_b64 exec, 1
    ds_add_rtn_u32 v9, v4, v8 offset:60
    s_mov_b64 exec, -1
    s_waitcnt vmcnt(2)
    s_add_u32 s37, s36, 0xc00000
    buffer_load_dwordx4 v[136:139], v1, s[4:7], s37 offen offset:0 nt
    v_mov_b32 v8, 1
    s_mov_b64 exec, 1
    ds_add_rtn_u32 v9, v4, v8 offset:60
    s_mov_b64 exec, -1
    s_waitcnt vmcnt(2)
    buffer_load_dwordx4 v[140:143], v1, s[4:7], s37 offen offset:128 nt
    v_mov_b32 v8, 1
    s_mov_b64 exec, 1
    ds_add_rtn_u32 v9, v4, v8 offset:60
    s_mov_b64 exec, -1
    s_waitcnt vmcnt(2)
    buffer_load_dwordx4 v[144:147], v1, s[4:7], s37 offen offset:2048 nt
    v_mov_b32 v3, 1
    s_mov_b64 exec, 1
    ds_add_u32 v4, v3 offset:28
    s_mov_b64 exec, -1
    v_mov_b32 v8, 1
    s_mov_b64 exec, 1
    ds_add_rtn_u32 v9, v4, v8 offset:60
    s_mov_b64 exec, -1
    s_waitcnt vmcnt(2)
    buffer_load_dwordx4 v[148:151], v1, s[4:7], s37 offen offset:2176 nt
    v_mov_b32 v8, 1
    s_mov_b64 exec, 1
    ds_add_rtn_u32 v9, v4, v8 offset:60
    s_mov_b64 exec, -1
    s_waitcnt vmcnt(2)
    s_add_u32 s37, s36, 0xc01000
    buffer_load_dwordx4 v[152:155], v1, s[4:7], s37 offen offset:0 nt
    v_mov_b32 v8, 1
    s_mov_b64 exec, 1
    ds_add_rtn_u32 v9, v4, v8 offset:60
    s_mov_b64 exec, -1
    s_waitcnt vmcnt(2)
    buffer_load_dwordx4 v[156:159], v1, s[4:7], s37 offen offset:128 nt
    v_mov_b32 v8, 1
    s_mov_b64 exec, 1
    ds_add_rtn_u32 v9, v4, v8 offset:60
    s_mov_b64 exec, -1
    s_waitcnt vmcnt(2)
    buffer_load_dwordx4 v[160:163], v1, s[4:7], s37 offen offset:2048 nt
    v_mov_b32 v8, 1
    s_mov_b64 exec, 1
    ds_add_rtn_u32 v9, v4, v8 offset:60
    s_mov_b64 exec, -1
    s_waitcnt vmcnt(2)
    buffer_load_dwordx4 v[164:167], v1, s[4:7], s37 offen offset:2176 nt
    v_mov_b32 v8, 1
    s_mov_b64 exec, 1
    ds_add_rtn_u32 v9, v4, v8 offset:60
    s_mov_b64 exec, -1
    s_mov_b32 s59, 0
L_sp_9:
    ds_read_b32 v3, v4 offset:0
    s_waitcnt lgkmcnt(0)
    v_cmp_gt_u32 vcc, 4, v3
    s_cbranch_vccz L_spx_10
    s_sleep 2
    s_add_u32 s59, s59, 1
    s_cmp_lt_u32 s59, 0x800000
    s_cbranch_scc1 L_sp_9
L_spx_10:
    ds_read_b128 v[8:11], v5 offset:6144
    ds_read_b128 v[12:15], v5 offset:6272
    s_waitcnt lgkmcnt(0)
    v_mfma_f32_16x16x32_bf16 v[16:19], v[40:43], v[8:11], 0
    v_mfma_f32_16x16x32_bf16 v[16:19], v[44:47], v[12:15], v[16:19]
    v_mfma_f32_16x16x32_bf16 v[20:23], v[48:51], v[8:11], 0
    v_mfma_f32_16x16x32_bf16 v[20:23], v[52:55], v[12:15], v[20:23]
    s_nop 5
    v_add_f32_dpp v24, v17, v16 row_ror:8 row_mask:0xf bank_mask:0x3
    s_nop 1
    v_add_f32_dpp v24, v18, v19 row_ror:8 row_mask:0xf bank_mask:0xc
    v_mfma_f32_16x16x32_bf16 v[16:19], v[56:59], v[8:11], 0
    v_mfma_f32_16x16x32_bf16 v[16:19], v[60:63], v[12:15], v[16:19]
    v_add_f32_dpp v25, v21, v20 row_ror:8 row_mask:0xf bank_mask:0x3
    s_nop 1
    v_add_f32_dpp v25, v22, v23 row_ror:8 row_mask:0xf bank_mask:0xc
    v_mfma_f32_16x16x32_bf16 v[20:23], v[64:67], v[8:11], 0
    v_mfma_f32_16x16x32_bf16 v[20:23], v[68:71], v[12:15], v[20:23]
    v_cvt_pk_bf16_f32 v3, v24, v25
    v_lshlrev_b32 v24, 16, v3
    v_and_b32 v25, 0xffff0000, v3
    v_mul_f32 v24, 0x3db504f3, v24
    v_mul_f32 v25, 0x3db504f3, v25
    v_cvt_pk_bf16_f32 v3, v24, v25
    v_lshlrev_b32 v24, 16, v3
    v_and_b32 v25, 0xffff0000, v3
    v_add_f32_dpp v26, v17, v16 row_ror:8 row_mask:0xf bank_mask:0x3
    s_nop 1
    v_add_f32_dpp v26, v18, v19 row_ror:8 row_mask:0xf bank_mask:0xc
    v_mfma_f32_16x16x32_bf16 v[16:19], v[72:75], v[8:11], 0
    v_mfma_f32_16x16x32_bf16 v[16:19], v[76:79], v[12:15], v[16:19]
    v_add_f32_dpp v27, v21, v20 row_ror:8 row_mask:0xf bank_mask:0x3
    s_nop 1
    v_add_f32_dpp v27, v22, v23 row_ror:8 row_mask:0xf bank_mask:0xc
    v_mfma_f32_16x16x32_bf16 v[20:23], v[80:83], v[8:11], 0
    v_mfma_f32_16x16x32_bf16 v[20:23], v[84:87], v[12:15], v[20:23]
    s_add_u32 s37, s36, 0x0
    buffer_load_dwordx4 v[40:43], v2, s[48:51], s37 offen offset:0 nt
    v_mov_b32 v3, 1
    s_mov_b64 exec, 1
    ds_add_u32 v4, v3 offset:60
    s_mov_b64 exec, -1
    v_cvt_pk_bf16_f32 v3, v26, v27
    v_lshlrev_b32 v26, 16, v3
    v_and_b32 v27, 0xffff0000, v3
    v_mul_f32 v26, 0x3db504f3, v26
    v_mul_f32 v27, 0x3db504f3, v27
    v_cvt_pk_bf16_f32 v3, v26, v27
    v_lshlrev_b32 v26, 16, v3
    v_and_b32 v27, 0xffff0000, v3
    v_add_f32_dpp v28, v17, v16 row_ror:8 row_mask:0xf bank_mask:0x3
    s_nop 1
    v_add_f32_dpp v28, v18, v19 row_ror:8 row_mask:0xf bank_mask:0xc
    v_mfma_f32_16x16x32_bf16 v[16:19], v[88:91], v[8:11], 0
    v_mfma_f32_16x16x32_bf16 v[16:19], v[92:95], v[12:15], v[16:19]
    v_add_f32_dpp v29, v21, v20 row_ror:8 row_mask:0xf bank_mask:0x3
    s_nop 1
    v_add_f32_dpp v29, v22, v23 row_ror:8 row_mask:0xf bank_mask:0xc
    v_mfma_f32_16x16x32_bf16 v[20:23], v[96:99], v[8:11], 0
    v_mfma_f32_16x16x32_bf16 v[20:23], v[100:103], v[12:15], v[20:23]
    v_cvt_pk_bf16_f32 v3, v28, v29
    v_lshlrev_b32 v28, 16, v3
    v_and_b32 v29, 0xffff0000, v3
    v_mul_f32 v28, 0x3db504f3, v28
    v_mul_f32 v29, 0x3db504f3, v29
    v_cvt_pk_bf16_f32 v3, v28, v29
    v_lshlrev_b32 v28, 16, v3
    v_and_b32 v29, 0xffff0000, v3
    v_add_f32_dpp v30, v17, v16 row_ror:8 row_mask:0xf bank_mask:0x3
    s_nop 1
    v_add_f32_dpp v30, v18, v19 row_ror:8 row_mask:0xf bank_mask:0xc
    v_mfma_f32_16x16x32_bf16 v[16:19], v[104:107], v[8:11], 0
    v_mfma_f32_16x16x32_bf16 v[16:19], v[108:111], v[12:15], v[16:19]
    v_add_f32_dpp v31, v21, v20 row_ror:8 row_mask:0xf bank_mask:0x3
    s_nop 1
    v_add_f32_dpp v31, v22, v23 row_ror:8 row_mask:0xf bank_mask:0xc
    v_mfma_f32_16x16x32_bf16 v[20:23], v[112:115], v[8:11], 0
    v_mfma_f32_16x16x32_bf16 v[20:23], v[116:119], v[12:15], v[20:23]
    s_add_u32 s37, s36, 0x0
    buffer_load_dwordx4 v[56:59], v2, s[48:51], s37 offen offset:1024 nt
    v_mov_b32 v3, 1
    s_mov_b64 exec, 1
    ds_add_u32 v4, v3 offset:60
    s_mov_b64 exec, -1
    v_cvt_pk_bf16_f32 v3, v30, v31
    v_lshlrev_b32 v30, 16, v3
    v_and_b32 v31, 0xffff0000, v3
    v_mul_f32 v30, 0x3db504f3, v30
    v_mul_f32 v31, 0x3db504f3, v31
    v_cvt_pk_bf16_f32 v3, v30, v31
    v_lshlrev_b32 v30, 16, v3
    v_and_b32 v31, 0xffff0000, v3
    v_add_f32_dpp v32, v17, v16 row_ror:8 row_mask:0xf bank_mask:0x3
    s_nop 1
    v_add_f32_dpp v32, v18, v19 row_ror:8 row_mask:0xf bank_mask:0xc
    v_mfma_f32_16x16x32_bf16 v[16:19], v[120:123], v[8:11], 0
    v_mfma_f32_16x16x32_bf16 v[16:19], v[124:127], v[12:15], v[16:19]
    v_add_f32_dpp v33, v21, v20 row_ror:8 row_mask:0xf bank_mask:0x3
    s_nop 1
    v_add_f32_dpp v33, v22, v23 row_ror:8 row_mask:0xf bank_mask:0xc
    v_mfma_f32_16x16x32_bf16 v[20:23], v[128:131], v[8:11], 0
    v_mfma_f32_16x16x32_bf16 v[20:23], v[132:135], v[12:15], v[20:23]
    v_cvt_pk_bf16_f32 v3, v32, v33
    v_lshlrev_b32 v32, 16, v3
    v_and_b32 v33, 0xffff0000, v3
    v_mul_f32 v32, 0x3db504f3, v32
    v_mul_f32 v33, 0x3db504f3, v33
    v_cvt_pk_bf16_f32 v3, v32, v33
    v_lshlrev_b32 v32, 16, v3
    v_and_b32 v33, 0xffff0000, v3
    v_add_f32_dpp v34, v17, v16 row_ror:8 row_mask:0xf bank_mask:0x3
    s_nop 1
    v_add_f32_dpp v34, v18, v19 row_ror:8 row_mask:0xf bank_mask:0xc
    v_mfma_f32_16x16x32_bf16 v[16:19], v[136:139], v[8:11], 0
    v_mfma_f32_16x16x32_bf16 v[16:19], v[140:143], v[12:15], v[16:19]
    v_add_f32_dpp v35, v21, v20 row_ror:8 row_mask:0xf bank_mask:0x3
    s_nop 1
    v_add_f32_dpp v35, v22, v23 row_ror:8 row_mask:0xf bank_mask:0xc
    v_mfma_f32_16x16x32_bf16 v[20:23], v[144:147], v[8:11], 0
    v_mfma_f32_16x16x32_bf16 v[20:23], v[148:151], v[12:15], v[20:23]
    v_cvt_pk_bf16_f32 v3, v34, v35
    v_lshlrev_b32 v34, 16, v3
    v_and_b32 v35, 0xffff0000, v3
    v_mul_f32 v34, 0x3db504f3, v34
    v_mul_f32 v35, 0x3db504f3, v35
    v_cvt_pk_bf16_f32 v3, v34, v35
    v_lshlrev_b32 v34, 16, v3
    v_and_b32 v35, 0xffff0000, v3
    v_add_f32_dpp v36, v17, v16 row_ror:8 row_mask:0xf bank_mask:0x3
    s_nop 1
    v_add_f32_dpp v36, v18, v19 row_ror:8 row_mask:0xf bank_mask:0xc
    s_waitcnt vmcnt(2)
    v_mfma_f32_16x16x32_bf16 v[16:19], v[152:155], v[8:11], 0
    v_mfma_f32_16x16x32_bf16 v[16:19], v[156:159], v[12:15], v[16:19]
    v_add_f32_dpp v37, v21, v20 row_ror:8 row_mask:0xf bank_mask:0x3
    s_nop 1
    v_add_f32_dpp v37, v22, v23 row_ror:8 row_mask:0xf bank_mask:0xc
    s_waitcnt vmcnt(2)
    v_mfma_f32_16x16x32_bf16 v[20:23], v[160:163], v[8:11], 0
    v_mfma_f32_16x16x32_bf16 v[20:23], v[164:167], v[12:15], v[20:23]
    v_cvt_pk_bf16_f32 v3, v36, v37
    v_lshlrev_b32 v36, 16, v3
    v_and_b32 v37, 0xffff0000, v3
    v_mul_f32 v36, 0x3db504f3, v36
    v_mul_f32 v37, 0x3db504f3, v37
    v_cvt_pk_bf16_f32 v3, v36, v37
    v_lshlrev_b32 v36, 16, v3
    v_and_b32 v37, 0xffff0000, v3
    v_add_f32_dpp v38, v17, v16 row_ror:8 row_mask:0xf bank_mask:0x3
    s_nop 1
    v_add_f32_dpp v38, v18, v19 row_ror:8 row_mask:0xf bank_mask:0xc
    v_add_f32_dpp v39, v21, v20 row_ror:8 row_mask:0xf bank_mask:0x3
    s_nop 1
    v_add_f32_dpp v39, v22, v23 row_ror:8 row_mask:0xf bank_mask:0xc
    s_add_u32 s37, s36, 0x0
    buffer_load_dwordx4 v[44:47], v2, s[48:51], s37 offen offset:2048 nt
    v_cvt_pk_bf16_f32 v3, v38, v39
    v_lshlrev_b32 v38, 16, v3
    v_and_b32 v39, 0xffff0000, v3
    v_mul_f32 v38, 0x3db504f3, v38
    v_mul_f32 v39, 0x3db504f3, v39
    v_cvt_pk_bf16_f32 v3, v38, v39
    v_lshlrev_b32 v38, 16, v3
    v_and_b32 v39, 0xffff0000, v3
    v_max3_f32 v6, v24, v25, v26
    v_max3_f32 v6, v6, v27, v28
    v_max3_f32 v6, v6, v29, v30
    v_max3_f32 v6, v6, v31, v32
    v_max3_f32 v6, v6, v33, v34
    v_max3_f32 v6, v6, v35, v36
    v_max3_f32 v6, v6, v37, v38
    v_max_f32 v6, v6, v39
    v_sub_f32 v8, v24, v6
    v_sub_f32 v9, v25, v6
    v_sub_f32 v10, v26, v6
    v_sub_f32 v11, v27, v6
    v_sub_f32 v12, v28, v6
    v_sub_f32 v13, v29, v6
    v_sub_f32 v14, v30, v6
    v_sub_f32 v15, v31, v6
    v_mul_f32 v8, 0x3fb8aa3b, v8
    v_mul_f32 v9, 0x3fb8aa3b, v9
    v_mul_f32 v10, 0x3fb8aa3b, v10
    v_mul_f32 v11, 0x3fb8aa3b, v11
    v_mul_f32 v12, 0x3fb8aa3b, v12
    v_mul_f32 v13, 0x3fb8aa3b, v13
    v_mul_f32 v14, 0x3fb8aa3b, v14
    v_mul_f32 v15, 0x3fb8aa3b, v15
    v_exp_f32 v8, v8
    v_exp_f32 v9, v9
    v_exp_f32 v10, v10
    v_exp_f32 v11, v11
    v_exp_f32 v12, v12
    v_exp_f32 v13, v13
    v_exp_f32 v14, v14
    v_exp_f32 v15, v15
    v_add_f32 v8, v8, v12
    v_add_f32 v9, v9, v13
    v_add_f32 v10, v10, v14
    v_add_f32 v11, v11, v15
    v_add_f32 v8, v8, v9
    v_add_f32 v10, v10, v11
    v_add_f32 v7, v8, v10
    v_sub_f32 v8, v32, v6
    v_sub_f32 v9, v33, v6
    v_sub_f32 v10, v34, v6
    v_sub_f32 v11, v35, v6
    v_sub_f32 v12, v36, v6
    v_sub_f32 v13, v37, v6
    v_sub_f32 v14, v38, v6
    v_sub_f32 v15, v39, v6
    v_mul_f32 v8, 0x3fb8aa3b, v8
    v_mul_f32 v9, 0x3fb8aa3b, v9
    v_mul_f32 v10, 0x3fb8aa3b, v10
    v_mul_f32 v11, 0x3fb8aa3b, v11
    v_mul_f32 v12, 0x3fb8aa3b, v12
    v_mul_f32 v13, 0x3fb8aa3b, v13
    v_mul_f32 v14, 0x3fb8aa3b, v14
    v_mul_f32 v15, 0x3fb8aa3b, v15
    v_exp_f32 v8, v8
    v_exp_f32 v9, v9
    v_exp_f32 v10, v10
    v_exp_f32 v11, v11
    v_exp_f32 v12, v12
    v_exp_f32 v13, v13
    v_exp_f32 v14, v14
    v_exp_f32 v15, v15
    v_add_f32 v8, v8, v12
    v_add_f32 v9, v9, v13
    v_add_f32 v10, v10, v14
    v_add_f32 v11, v11, v15
    v_add_f32 v8, v8, v9
    v_add_f32 v10, v10, v11
    v_add_f32 v8, v8, v10
    v_add_f32 v7, v7, v8
    v_and_b32 v8, 7, v0
    v_lshlrev_b32 v5, 3, v8
    v_lshlrev_b32 v8, 9, v8
    v_lshrrev_b32 v9, 3, v0
    v_lshl_add_u32 v8, v9, 3, v8
    s_lshl_b32 s38, s35, 6
    v_add_u32 v8, s38, v8
    ds_write_b64 v8, v[6:7] offset:8192
    v_mov_b32 v3, 1
    s_mov_b64 exec, 1
    ds_add_u32 v4, v3 offset:4
    s_mov_b64 exec, -1
    v_mov_b32 v8, 1
    s_mov_b64 exec, 1
    ds_add_rtn_u32 v9, v4, v8 offset:60
    s_mov_b64 exec, -1
    s_waitcnt vmcnt(5) lgkmcnt(0)
    v_readfirstlane_b32 s52, v9
    s_nop 0
    s_cmp_gt_i32 s52, 292
    s_cbranch_scc1 L_bc_11
    s_waitcnt vmcnt(2)
L_bc_11:
    s_add_u32 s37, s36, 0x0
    buffer_load_dwordx4 v[60:63], v2, s[48:51], s37 offen offset:3072 nt
    v_mov_b32 v8, 1
    s_mov_b64 exec, 1
    ds_add_rtn_u32 v9, v4, v8 offset:60
    s_mov_b64 exec, -1
    s_waitcnt vmcnt(5) lgkmcnt(0)
    v_readfirstlane_b32 s52, v9
    s_nop 0
    s_cmp_gt_i32 s52, 300
    s_cbranch_scc1 L_bc_12
    s_waitcnt vmcnt(2)
L_bc_12:
    s_add_u32 s37, s36, 0x1000
    buffer_load_dwordx4 v[48:51], v2, s[48:51], s37 offen offset:0 nt
    v_mov_b32 v8, 1
    s_mov_b64 exec, 1
    ds_add_rtn_u32 v9, v4, v8 offset:60
    s_mov_b64 exec, -1
    v_and_b32 v18, 15, v0
    v_mul_u32_u24 v18, 272, v18
    v_lshrrev_b32 v3, 4, v0
    v_lshl_add_u32 v18, v3, 4, v18
    s_mul_i32 s43, s35, 4352
    v_add_u32 v18, s43, v18
    s_and_b32 s40, s35, 3
    s_and_b32 s39, s2, 0xf7
    s_and_b32 s43, s35, 4
    s_lshl_b32 s43, s43, 1
    s_or_b32 s39, s39, s43
    s_cmp_ge_u32 s2, 224
    s_cselect_b32 s39, s2, s39
    s_lshl_b32 s43, s40, 8
    s_and_b32 s46, s39, 7
    s_mul_i32 s46, s46, 28
    s_lshr_b32 s47, s39, 3
    s_add_u32 s46, s46, s47
    s_and_b32 s47, s46, 1
    s_lshl_b32 s47, s47, 10
    s_add_u32 s47, s47, s43
    v_and_b32 v1, 15, v0
    v_lshlrev_b32 v1, 4, v1
    v_lshl_add_u32 v17, v3, 14, v1
    v_lshl_add_u32 v1, v3, 11, v1
    s_lshr_b32 s38, s39, 6
    s_lshl_b32 s38, s38, 21
    s_bfe_u32 s43, s39, 0x30003
    s_lshl_b32 s43, s43, 2
    s_add_u32 s43, s43, s40
    s_lshl_b32 s43, s43, 13
    s_add_u32 s38, s38, s43
    s_and_b32 s43, s39, 7
    s_lshl_b32 s43, s43, 8
    s_add_u32 s38, s38, s43
    s_lshr_b32 s41, s46, 1
    s_lshl_b32 s41, s41, 16
    s_add_u32 s41, s41, s47
    v_and_b32 v19, 3, v0
    v_lshlrev_b32 v19, 5, v19
    v_lshl_add_u32 v19, v3, 4, v19
    v_bfe_u32 v16, v0, 2, 1
    v_lshl_add_u32 v20, v16, 12, v19
    v_bfe_u32 v16, v0, 3, 1
    v_lshl_add_u32 v20, v16, 7, v20
    v_bfe_u32 v16, v0, 2, 2
    v_lshl_add_u32 v19, v16, 14, v19
    s_and_b32 s44, s39, 7
    s_lshl_b32 s44, s44, 7
    s_lshr_b32 s43, s39, 3
    s_add_u32 s44, s44, s43
    s_lshl_b32 s44, s44, 2
    s_add_u32 s44, s44, s40
    s_lshl_b32 s44, s44, 7
    s_add_u32 s44, s44, 0x200000
    s_lshl_b32 s45, s47, 9
    s_bfe_u32 s43, s46, 0x60001
    s_lshl_b32 s43, s43, 7
    s_add_u32 s45, s45, s43
    s_lshr_b32 s43, s46, 7
    s_lshl_b32 s43, s43, 14
    s_add_u32 s45, s45, s43
    s_mov_b32 s43, 0
    s_lshl_b32 s43, s43, 13
    s_add_u32 s45, s45, s43
    s_add_u32 s45, s45, 0x100000
    v_lshlrev_b32 v21, 4, v3
    s_lshl_b32 s43, s35, 7
    v_add_u32 v23, s43, v21
    s_lshr_b32 s42, s39, 3
    s_lshl_b32 s42, s42, 2
    s_add_u32 s42, s42, s40
    s_lshl_b32 s42, s42, 8
    s_add_u32 s42, s42, 0xb0000
    s_lshl_b32 s43, s35, 6
    v_add_u32 v22, s43, v21
    s_waitcnt vmcnt(5) lgkmcnt(0)
    v_readfirstlane_b32 s52, v9
    s_nop 0
    s_cmp_gt_i32 s52, 308
    s_cbranch_scc1 L_bc_13
    s_waitcnt vmcnt(2)
L_bc_13:
    s_add_u32 s37, s36, 0x1000
    buffer_load_dwordx4 v[64:67], v2, s[48:51], s37 offen offset:1024 nt
    v_mov_b32 v8, 1
    s_mov_b64 exec, 1
    ds_add_rtn_u32 v9, v4, v8 offset:60
    s_mov_b64 exec, -1
    s_waitcnt vmcnt(5) lgkmcnt(0)
    v_readfirstlane_b32 s52, v9
    s_nop 0
    s_cmp_gt_i32 s52, 316
    s_cbranch_scc1 L_bc_14
    s_waitcnt vmcnt(2)
L_bc_14:
    s_add_u32 s37, s36, 0x1000
    buffer_load_dwordx4 v[52:55], v2, s[48:51], s37 offen offset:2048 nt
    v_mov_b32 v8, 1
    s_mov_b64 exec, 1
    ds_add_rtn_u32 v9, v4, v8 offset:60
    s_mov_b64 exec, -1
    s_waitcnt vmcnt(5) lgkmcnt(0)
    v_readfirstlane_b32 s52, v9
    s_nop 0
    s_cmp_gt_i32 s52, 324
    s_cbranch_scc1 L_bc_15
    s_waitcnt vmcnt(2)
L_bc_15:
    s_add_u32 s37, s36, 0x1000
    buffer_load_dwordx4 v[68:71], v2, s[48:51], s37 offen offset:3072 nt
    v_mov_b32 v8, 1
    s_mov_b64 exec, 1
    ds_add_rtn_u32 v9, v4, v8 offset:60
    s_mov_b64 exec, -1
    s_waitcnt vmcnt(5) lgkmcnt(0)
    v_readfirstlane_b32 s52, v9
    s_nop 0
    s_cmp_gt_i32 s52, 332
    s_cbranch_scc1 L_bc_16
    s_waitcnt vmcnt(2)
L_bc_16:
    s_add_u32 s37, s36, 0x400000
    buffer_load_dwordx4 v[72:75], v2, s[48:51], s37 offen offset:0 nt
    v_mov_b32 v8, 1
    s_mov_b64 exec, 1
    ds_add_rtn_u32 v9, v4, v8 offset:60
    s_mov_b64 exec, -1
    s_waitcnt vmcnt(5) lgkmcnt(0)
    v_readfirstlane_b32 s52, v9
    s_nop 0
    s_cmp_gt_i32 s52, 340
    s_cbranch_scc1 L_bc_17
    s_waitcnt vmcnt(2)
L_bc_17:
    s_add_u32 s37, s36, 0x400000
    buffer_load_dwordx4 v[88:91], v2, s[48:51], s37 offen offset:1024 nt
    v_mov_b32 v8, 1
    s_mov_b64 exec, 1
    ds_add_rtn_u32 v9, v4, v8 offset:60
    s_mov_b64 exec, -1
    s_waitcnt vmcnt(5) lgkmcnt(0)
    v_readfirstlane_b32 s52, v9
    s_nop 0
    s_cmp_gt_i32 s52, 348
    s_cbranch_scc1 L_bc_18
    s_waitcnt vmcnt(2)
L_bc_18:
    s_add_u32 s37, s36, 0x400000
    buffer_load_dwordx4 v[76:79], v2, s[48:51], s37 offen offset:2048 nt
    v_mov_b32 v8, 1
    s_mov_b64 exec, 1
    ds_add_rtn_u32 v9, v4, v8 offset:60
    s_mov_b64 exec, -1
    s_waitcnt vmcnt(5) lgkmcnt(0)
    v_readfirstlane_b32 s52, v9
    s_nop 0
    s_cmp_gt_i32 s52, 356
    s_cbranch_scc1 L_bc_19
    s_waitcnt vmcnt(2)
L_bc_19:
    s_add_u32 s37, s36, 0x400000
    buffer_load_dwordx4 v[92:95], v2, s[48:51], s37 offen offset:3072 nt
    v_mov_b32 v8, 1
    s_mov_b64 exec, 1
    ds_add_rtn_u32 v9, v4, v8 offset:60
    s_mov_b64 exec, -1
    s_waitcnt vmcnt(5) lgkmcnt(0)
    v_readfirstlane_b32 s52, v9
    s_nop 0
    s_cmp_gt_i32 s52, 364
    s_cbranch_scc1 L_bc_20
    s_waitcnt vmcnt(2)
L_bc_20:
    s_add_u32 s37, s36, 0x401000
    buffer_load_dwordx4 v[80:83], v2, s[48:51], s37 offen offset:0 nt
    v_mov_b32 v8, 1
    s_mov_b64 exec, 1
    ds_add_rtn_u32 v9, v4, v8 offset:60
    s_mov_b64 exec, -1
    s_waitcnt vmcnt(5) lgkmcnt(0)
    v_readfirstlane_b32 s52, v9
    s_nop 0
    s_cmp_gt_i32 s52, 372
    s_cbranch_scc1 L_bc_21
    s_waitcnt vmcnt(2)
L_bc_21:
    s_add_u32 s37, s36, 0x401000
    buffer_load_dwordx4 v[96:99], v2, s[48:51], s37 offen offset:1024 nt
    v_mov_b32 v8, 1
    s_mov_b64 exec, 1
    ds_add_rtn_u32 v9, v4, v8 offset:60
    s_mov_b64 exec, -1
    s_waitcnt vmcnt(5) lgkmcnt(0)
    v_readfirstlane_b32 s52, v9
    s_nop 0
    s_cmp_gt_i32 s52, 380
    s_cbranch_scc1 L_bc_22
    s_waitcnt vmcnt(2)
L_bc_22:
    s_add_u32 s37, s36, 0x401000
    buffer_load_dwordx4 v[84:87], v2, s[48:51], s37 offen offset:2048 nt
    v_mov_b32 v8, 1
    s_mov_b64 exec, 1
    ds_add_rtn_u32 v9, v4, v8 offset:60
    s_mov_b64 exec, -1
    s_waitcnt vmcnt(5) lgkmcnt(0)
    v_readfirstlane_b32 s52, v9
    s_nop 0
    s_cmp_gt_i32 s52, 388
    s_cbranch_scc1 L_bc_23
    s_waitcnt vmcnt(2)
L_bc_23:
    s_add_u32 s37, s36, 0x401000
    buffer_load_dwordx4 v[100:103], v2, s[48:51], s37 offen offset:3072 nt
    v_mov_b32 v8, 1
    s_mov_b64 exec, 1
    ds_add_rtn_u32 v9, v4, v8 offset:60
    s_mov_b64 exec, -1
    s_waitcnt vmcnt(5) lgkmcnt(0)
    v_readfirstlane_b32 s52, v9
    s_nop 0
    s_cmp_gt_i32 s52, 396
    s_cbranch_scc1 L_bc_24
    s_waitcnt vmcnt(2)
L_bc_24:
    s_add_u32 s37, s36, 0x800000
    buffer_load_dwordx4 v[104:107], v2, s[48:51], s37 offen offset:0 nt
    v_mov_b32 v8, 1
    s_mov_b64 exec, 1
    ds_add_rtn_u32 v9, v4, v8 offset:60
    s_mov_b64 exec, -1
    v_mov_b32 v3, 1
    s_mov_b64 exec, 1
    ds_add_u32 v4, v3 offset:28
    s_mov_b64 exec, -1
    s_waitcnt vmcnt(5) lgkmcnt(0)
    v_readfirstlane_b32 s52, v9
    s_nop 0
    s_cmp_gt_i32 s52, 404
    s_cbranch_scc1 L_bc_25
    s_waitcnt vmcnt(2)
L_bc_25:
    s_add_u32 s37, s36, 0x800000
    buffer_load_dwordx4 v[120:123], v2, s[48:51], s37 offen offset:1024 nt
    v_mov_b32 v8, 1
    s_mov_b64 exec, 1
    ds_add_rtn_u32 v9, v4, v8 offset:60
    s_mov_b64 exec, -1
    s_waitcnt vmcnt(5) lgkmcnt(0)
    v_readfirstlane_b32 s52, v9
    s_nop 0
    s_cmp_gt_i32 s52, 412
    s_cbranch_scc1 L_bc_26
    s_waitcnt vmcnt(2)
L_bc_26:
    s_add_u32 s37, s36, 0x800000
    buffer_load_dwordx4 v[108:111], v2, s[48:51], s37 offen offset:2048 nt
    v_mov_b32 v8, 1
    s_mov_b64 exec, 1
    ds_add_rtn_u32 v9, v4, v8 offset:60
    s_mov_b64 exec, -1
    s_waitcnt vmcnt(5) lgkmcnt(0)
    v_readfirstlane_b32 s52, v9
    s_nop 0
    s_cmp_gt_i32 s52, 420
    s_cbranch_scc1 L_bc_27
    s_waitcnt vmcnt(2)
L_bc_27:
    s_add_u32 s37, s36, 0x800000
    buffer_load_dwordx4 v[124:127], v2, s[48:51], s37 offen offset:3072 nt
    v_mov_b32 v8, 1
    s_mov_b64 exec, 1
    ds_add_rtn_u32 v9, v4, v8 offset:60
    s_mov_b64 exec, -1
    s_waitcnt vmcnt(5) lgkmcnt(0)
    v_readfirstlane_b32 s52, v9
    s_nop 0
    s_cmp_gt_i32 s52, 428
    s_cbranch_scc1 L_bc_28
    s_waitcnt vmcnt(2)
L_bc_28:
    s_add_u32 s37, s36, 0x801000
    buffer_load_dwordx4 v[112:115], v2, s[48:51], s37 offen offset:0 nt
    v_mov_b32 v8, 1
    s_mov_b64 exec, 1
    ds_add_rtn_u32 v9, v4, v8 offset:60
    s_mov_b64 exec, -1
    s_waitcnt vmcnt(5) lgkmcnt(0)
    v_readfirstlane_b32 s52, v9
    s_nop 0
    s_cmp_gt_i32 s52, 436
    s_cbranch_scc1 L_bc_29
    s_waitcnt vmcnt(2)
L_bc_29:
    s_add_u32 s37, s36, 0x801000
    buffer_load_dwordx4 v[128:131], v2, s[48:51], s37 offen offset:1024 nt
    v_mov_b32 v8, 1
    s_mov_b64 exec, 1
    ds_add_rtn_u32 v9, v4, v8 offset:60
    s_mov_b64 exec, -1
    s_waitcnt vmcnt(5) lgkmcnt(0)
    v_readfirstlane_b32 s52, v9
    s_nop 0
    s_cmp_gt_i32 s52, 444
    s_cbranch_scc1 L_bc_30
    s_waitcnt vmcnt(2)
L_bc_30:
    s_add_u32 s37, s36, 0x801000
    buffer_load_dwordx4 v[116:119], v2, s[48:51], s37 offen offset:2048 nt
    v_mov_b32 v8, 1
    s_mov_b64 exec, 1
    ds_add_rtn_u32 v9, v4, v8 offset:60
    s_mov_b64 exec, -1
    s_waitcnt vmcnt(5) lgkmcnt(0)
    v_readfirstlane_b32 s52, v9
    s_nop 0
    s_cmp_gt_i32 s52, 452
    s_cbranch_scc1 L_bc_31
    s_waitcnt vmcnt(2)
L_bc_31:
    s_add_u32 s37, s36, 0x801000
    buffer_load_dwordx4 v[132:135], v2, s[48:51], s37 offen offset:3072 nt
    v_mov_b32 v8, 1
    s_mov_b64 exec, 1
    ds_add_rtn_u32 v9, v4, v8 offset:60
    s_mov_b64 exec, -1
    s_mov_b32 s59, 0
L_sp_32:
    ds_read_b32 v3, v4 offset:8
    s_waitcnt lgkmcnt(0)
    v_cmp_gt_u32 vcc, 1, v3
    s_cbranch_vccz L_spx_33
    s_sleep 2
    s_add_u32 s59, s59, 1
    s_cmp_lt_u32 s59, 0x800000
    s_cbranch_scc1 L_sp_32
L_spx_33:
    ds_read_b64 v[6:7], v5 offset:64
    ds_read_b32 v3, v4 offset:44
    s_waitcnt lgkmcnt(0)
    v_readfirstlane_b32 s10, v3
    v_sub_f32 v24, v24, v6
    v_sub_f32 v25, v25, v6
    v_sub_f32 v26, v26, v6
    v_sub_f32 v27, v27, v6
    v_mul_f32 v24, 0x3fb8aa3b, v24
    v_mul_f32 v25, 0x3fb8aa3b, v25
    v_mul_f32 v26, 0x3fb8aa3b, v26
    v_mul_f32 v27, 0x3fb8aa3b, v27
    v_exp_f32 v24, v24
    v_exp_f32 v25, v25
    v_exp_f32 v26, v26
    v_exp_f32 v27, v27
    v_mul_f32 v24, v24, v7
    v_mul_f32 v25, v25, v7
    v_mul_f32 v26, v26, v7
    v_mul_f32 v27, v27, v7
    v_cvt_pk_bf16_f32 v24, v24, v25
    v_cvt_pk_bf16_f32 v25, v26, v27
    s_nop 0
    v_mov_b32_dpp v26, v24 row_ror:8 row_mask:0xf bank_mask:0xf
    v_mov_b32_dpp v27, v25 row_ror:8 row_mask:0xf bank_mask:0xf
    v_perm_b32 v8, v44, v40, s32
    v_perm_b32 v9, v52, v48, s32
    v_perm_b32 v10, v60, v56, s32
    v_perm_b32 v11, v68, v64, s32
    v_perm_b32 v12, v44, v40, s33
    v_perm_b32 v13, v52, v48, s33
    v_perm_b32 v14, v60, v56, s33
    v_perm_b32 v15, v68, v64, s33
    v_mfma_f32_16x16x32_bf16 v[136:139], v[24:27], v[8:11], 0
    v_perm_b32 v8, v45, v41, s32
    v_perm_b32 v9, v53, v49, s32
    v_perm_b32 v10, v61, v57, s32
    v_perm_b32 v11, v69, v65, s32
    v_mfma_f32_16x16x32_bf16 v[140:143], v[24:27], v[12:15], 0
    v_perm_b32 v12, v45, v41, s33
    v_perm_b32 v13, v53, v49, s33
    v_perm_b32 v14, v61, v57, s33
    v_perm_b32 v15, v69, v65, s33
    v_mfma_f32_16x16x32_bf16 v[144:147], v[24:27], v[8:11], 0
    v_perm_b32 v8, v46, v42, s32
    v_perm_b32 v9, v54, v50, s32
    v_perm_b32 v10, v62, v58, s32
    v_perm_b32 v11, v70, v66, s32
    v_mfma_f32_16x16x32_bf16 v[148:151], v[24:27], v[12:15], 0
    v_perm_b32 v12, v46, v42, s33
    v_perm_b32 v13, v54, v50, s33
    v_perm_b32 v14, v62, v58, s33
    v_perm_b32 v15, v70, v66, s33
    v_mfma_f32_16x16x32_bf16 v[152:155], v[24:27], v[8:11], 0
    v_perm_b32 v8, v47, v43, s32
    v_perm_b32 v9, v55, v51, s32
    v_perm_b32 v10, v63, v59, s32
    v_perm_b32 v11, v71, v67, s32
    v_mfma_f32_16x16x32_bf16 v[156:159], v[24:27], v[12:15], 0
    v_perm_b32 v12, v47, v43, s33
    v_perm_b32 v13, v55, v51, s33
    v_perm_b32 v14, v63, v59, s33
    v_perm_b32 v15, v71, v67, s33
    v_mfma_f32_16x16x32_bf16 v[160:163], v[24:27], v[8:11], 0
    s_nop 0
    v_mfma_f32_16x16x32_bf16 v[164:167], v[24:27], v[12:15], 0
    s_add_u32 s37, s36, 0xc00000
    buffer_load_dwordx4 v[40:43], v2, s[48:51], s37 offen offset:0 nt
    v_mov_b32 v3, 1
    s_mov_b64 exec, 1
    ds_add_u32 v4, v3 offset:60
    s_mov_b64 exec, -1
    v_sub_f32 v28, v28, v6
    v_sub_f32 v29, v29, v6
    v_sub_f32 v30, v30, v6
    v_sub_f32 v31, v31, v6
    v_mul_f32 v28, 0x3fb8aa3b, v28
    v_mul_f32 v29, 0x3fb8aa3b, v29
    v_mul_f32 v30, 0x3fb8aa3b, v30
    v_mul_f32 v31, 0x3fb8aa3b, v31
    v_exp_f32 v28, v28
    v_exp_f32 v29, v29
    v_exp_f32 v30, v30
    v_exp_f32 v31, v31
    v_mul_f32 v28, v28, v7
    v_mul_f32 v29, v29, v7
    v_mul_f32 v30, v30, v7
    v_mul_f32 v31, v31, v7
    v_cvt_pk_bf16_f32 v28, v28, v29
    v_cvt_pk_bf16_f32 v29, v30, v31
    s_nop 0
    v_mov_b32_dpp v30, v28 row_ror:8 row_mask:0xf bank_mask:0xf
    v_mov_b32_dpp v31, v29 row_ror:8 row_mask:0xf bank_mask:0xf
    v_perm_b32 v8, v76, v72, s32
    v_perm_b32 v9, v84, v80, s32
    v_perm_b32 v10, v92, v88, s32
    v_perm_b32 v11, v100, v96, s32
    v_perm_b32 v12, v76, v72, s33
    v_perm_b32 v13, v84, v80, s33
    v_perm_b32 v14, v92, v88, s33
    v_perm_b32 v15, v100, v96, s33
    v_mfma_f32_16x16x32_bf16 v[136:139], v[28:31], v[8:11], v[136:139]
    v_perm_b32 v8, v77, v73, s32
    v_perm_b32 v9, v85, v81, s32
    v_perm_b32 v10, v93, v89, s32
    v_perm_b32 v11, v101, v97, s32
    v_mfma_f32_16x16x32_bf16 v[140:143], v[28:31], v[12:15], v[140:143]
    v_perm_b32 v12, v77, v73, s33
    v_perm_b32 v13, v85, v81, s33
    v_perm_b32 v14, v93, v89, s33
    v_perm_b32 v15, v101, v97, s33
    v_mfma_f32_16x16x32_bf16 v[144:147], v[28:31], v[8:11], v[144:147]
    v_perm_b32 v8, v78, v74, s32
    v_perm_b32 v9, v86, v82, s32
    v_perm_b32 v10, v94, v90, s32
    v_perm_b32 v11, v102, v98, s32
    v_mfma_f32_16x16x32_bf16 v[148:151], v[28:31], v[12:15], v[148:151]
    v_perm_b32 v12, v78, v74, s33
    v_perm_b32 v13, v86, v82, s33
    v_perm_b32 v14, v94, v90, s33
    v_perm_b32 v15, v102, v98, s33
    v_mfma_f32_16x16x32_bf16 v[152:155], v[28:31], v[8:11], v[152:155]
    v_perm_b32 v8, v79, v75, s32
    v_perm_b32 v9, v87, v83, s32
    v_perm_b32 v10, v95, v91, s32
    v_perm_b32 v11, v103, v99, s32
    v_mfma_f32_16x16x32_bf16 v[156:159], v[28:31], v[12:15], v[156:159]
    v_perm_b32 v12, v79, v75, s33
    v_perm_b32 v13, v87, v83, s33
    v_perm_b32 v14, v95, v91, s33
    v_perm_b32 v15, v103, v99, s33
    v_mfma_f32_16x16x32_bf16 v[160:163], v[28:31], v[8:11], v[160:163]
    s_nop 0
    v_mfma_f32_16x16x32_bf16 v[164:167], v[28:31], v[12:15], v[164:167]
    s_cmp_lt_u32 s2, 224
    s_cbranch_scc1 L_noearly
    s_cmp_ge_u32 s35, 4
    s_cbranch_scc1 L_noearly
    s_add_u32 s37, s38, 0x0
    buffer_load_dwordx4 v[72:75], v1, s[16:19], s37 offen nt
    s_add_u32 s37, s38, 0x40000
    buffer_load_dwordx4 v[76:79], v1, s[16:19], s37 offen nt
    s_add_u32 s37, s38, 0x80000
    buffer_load_dwordx4 v[80:83], v1, s[16:19], s37 offen nt
    s_add_u32 s37, s38, 0xc0000
    buffer_load_dwordx4 v[84:87], v1, s[16:19], s37 offen nt
    s_add_u32 s37, s38, 0x100000
    buffer_load_dwordx4 v[88:91], v1, s[16:19], s37 offen nt
    s_add_u32 s37, s38, 0x140000
    buffer_load_dwordx4 v[92:95], v1, s[16:19], s37 offen nt
    s_add_u32 s37, s38, 0x180000
    buffer_load_dwordx4 v[96:99], v1, s[16:19], s37 offen nt
    s_add_u32 s37, s38, 0x1c0000
    buffer_load_dwordx4 v[100:103], v1, s[16:19], s37 offen nt
L_noearly:
    v_sub_f32 v32, v32, v6
    v_sub_f32 v33, v33, v6
    v_sub_f32 v34, v34, v6
    v_sub_f32 v35, v35, v6
    v_mul_f32 v32, 0x3fb8aa3b, v32
    v_mul_f32 v33, 0x3fb8aa3b, v33
    v_mul_f32 v34, 0x3fb8aa3b, v34
    v_mul_f32 v35, 0x3fb8aa3b, v35
    v_exp_f32 v32, v32
    v_exp_f32 v33, v33
    v_exp_f32 v34, v34
    v_exp_f32 v35, v35
    v_mul_f32 v32, v32, v7
    v_mul_f32 v33, v33, v7
    v_mul_f32 v34, v34, v7
    v_mul_f32 v35, v35, v7
    v_cvt_pk_bf16_f32 v32, v32, v33
    v_cvt_pk_bf16_f32 v33, v34, v35
    s_nop 0
    v_mov_b32_dpp v34, v32 row_ror:8 row_mask:0xf bank_mask:0xf
    v_mov_b32_dpp v35, v33 row_ror:8 row_mask:0xf bank_mask:0xf
    v_sub_f32 v36, v36, v6
    v_sub_f32 v37, v37, v6
    v_sub_f32 v38, v38, v6
    v_sub_f32 v39, v39, v6
    v_mul_f32 v36, 0x3fb8aa3b, v36
    v_mul_f32 v37, 0x3fb8aa3b, v37
    v_mul_f32 v38, 0x3fb8aa3b, v38
    v_mul_f32 v39, 0x3fb8aa3b, v39
    v_exp_f32 v36, v36
    v_exp_f32 v37, v37
    v_exp_f32 v38, v38
    v_exp_f32 v39, v39
    v_mul_f32 v36, v36, v7
    v_mul_f32 v37, v37, v7
    v_mul_f32 v38, v38, v7
    v_mul_f32 v39, v39, v7
    v_cvt_pk_bf16_f32 v36, v36, v37
    v_cvt_pk_bf16_f32 v37, v38, v39
    s_nop 0
    v_mov_b32_dpp v38, v36 row_ror:8 row_mask:0xf bank_mask:0xf
    v_mov_b32_dpp v39, v37 row_ror:8 row_mask:0xf bank_mask:0xf
    v_mov_b32 v8, 0
    s_mov_b64 exec, 1
    ds_add_rtn_u32 v9, v4, v8 offset:60
    s_mov_b64 exec, -1
    s_waitcnt vmcnt(5) lgkmcnt(0)
    v_readfirstlane_b32 s52, v9
    s_nop 0
    s_cmp_gt_i32 s52, 468
    s_cbranch_scc1 L_bc_34
    s_waitcnt vmcnt(2)
L_bc_34:
    s_add_u32 s37, s36, 0xc00000
    buffer_load_dwordx4 v[56:59], v2, s[48:51], s37 offen offset:1024 nt
    v_mov_b32 v8, 1
    s_mov_b64 exec, 1
    ds_add_rtn_u32 v9, v4, v8 offset:60
    s_mov_b64 exec, -1
    s_waitcnt vmcnt(5) lgkmcnt(0)
    v_readfirstlane_b32 s52, v9
    s_nop 0
    s_cmp_gt_i32 s52, 476
    s_cbranch_scc1 L_bc_35
    s_waitcnt vmcnt(2)
L_bc_35:
    s_add_u32 s37, s36, 0xc00000
    buffer_load_dwordx4 v[44:47], v2, s[48:51], s37 offen offset:2048 nt
    v_mov_b32 v8, 1
    s_mov_b64 exec, 1
    ds_add_rtn_u32 v9, v4, v8 offset:60
    s_mov_b64 exec, -1
    s_waitcnt vmcnt(5) lgkmcnt(0)
    v_readfirstlane_b32 s52, v9
    s_nop 0
    s_cmp_gt_i32 s52, 484
    s_cbranch_scc1 L_bc_36
    s_waitcnt vmcnt(2)
L_bc_36:
    s_add_u32 s37, s36, 0xc00000
    buffer_load_dwordx4 v[60:63], v2, s[48:51], s37 offen offset:3072 nt
    v_mov_b32 v8, 1
    s_mov_b64 exec, 1
    ds_add_rtn_u32 v9, v4, v8 offset:60
    s_mov_b64 exec, -1
    s_waitcnt vmcnt(5) lgkmcnt(0)
    v_readfirstlane_b32 s52, v9
    s_nop 0
    s_cmp_gt_i32 s52, 492
    s_cbranch_scc1 L_bc_37
    s_waitcnt vmcnt(2)
L_bc_37:
    s_add_u32 s37, s36, 0xc01000
    buffer_load_dwordx4 v[48:51], v2, s[48:51], s37 offen offset:0 nt
    v_mov_b32 v8, 1
    s_mov_b64 exec, 1
    ds_add_rtn_u32 v9, v4, v8 offset:60
    s_mov_b64 exec, -1
    s_waitcnt vmcnt(5) lgkmcnt(0)
    v_readfirstlane_b32 s52, v9
    s_nop 0
    s_cmp_gt_i32 s52, 500
    s_cbranch_scc1 L_bc_38
    s_waitcnt vmcnt(2)
L_bc_38:
    s_add_u32 s37, s36, 0xc01000
    buffer_load_dwordx4 v[64:67], v2, s[48:51], s37 offen offset:1024 nt
    s_waitcnt vmcnt(6)
    v_mov_b32 v3, 1
    s_mov_b64 exec, 1
    ds_add_u32 v4, v3 offset:60
    s_mov_b64 exec, -1
    v_perm_b32 v8, v108, v104, s32
    v_perm_b32 v9, v116, v112, s32
    v_perm_b32 v10, v124, v120, s32
    v_perm_b32 v11, v132, v128, s32
    v_perm_b32 v12, v108, v104, s33
    v_perm_b32 v13, v116, v112, s33
    v_perm_b32 v14, v124, v120, s33
    v_perm_b32 v15, v132, v128, s33
    v_mfma_f32_16x16x32_bf16 v[136:139], v[32:35], v[8:11], v[136:139]
    v_perm_b32 v8, v109, v105, s32
    v_perm_b32 v9, v117, v113, s32
    v_perm_b32 v10, v125, v121, s32
    v_perm_b32 v11, v133, v129, s32
    v_mfma_f32_16x16x32_bf16 v[140:143], v[32:35], v[12:15], v[140:143]
    v_perm_b32 v12, v109, v105, s33
    v_perm_b32 v13, v117, v113, s33
    v_perm_b32 v14, v125, v121, s33
    v_perm_b32 v15, v133, v129, s33
    v_mfma_f32_16x16x32_bf16 v[144:147], v[32:35], v[8:11], v[144:147]
    v_perm_b32 v8, v110, v106, s32
    v_perm_b32 v9, v118, v114, s32
    v_perm_b32 v10, v126, v122, s32
    v_perm_b32 v11, v134, v130, s32
    v_mfma_f32_16x16x32_bf16 v[148:151], v[32:35], v[12:15], v[148:151]
    v_perm_b32 v12, v110, v106, s33
    v_perm_b32 v13, v118, v114, s33
    v_perm_b32 v14, v126, v122, s33
    v_perm_b32 v15, v134, v130, s33
    v_mfma_f32_16x16x32_bf16 v[152:155], v[32:35], v[8:11], v[152:155]
    v_perm_b32 v8, v111, v107, s32
    v_perm_b32 v9, v119, v115, s32
    v_perm_b32 v10, v127, v123, s32
    v_perm_b32 v11, v135, v131, s32
    v_mfma_f32_16x16x32_bf16 v[156:159], v[32:35], v[12:15], v[156:159]
    v_perm_b32 v12, v111, v107, s33
    v_perm_b32 v13, v119, v115, s33
    v_perm_b32 v14, v127, v123, s33
    v_perm_b32 v15, v135, v131, s33
    v_mfma_f32_16x16x32_bf16 v[160:163], v[32:35], v[8:11], v[160:163]
    s_nop 0
    v_mfma_f32_16x16x32_bf16 v[164:167], v[32:35], v[12:15], v[164:167]
    v_mov_b32 v8, 0
    s_mov_b64 exec, 1
    ds_add_rtn_u32 v9, v4, v8 offset:60
    s_mov_b64 exec, -1
    s_waitcnt vmcnt(5) lgkmcnt(0)
    v_readfirstlane_b32 s52, v9
    s_nop 0
    s_cmp_gt_i32 s52, 508
    s_cbranch_scc1 L_bc_39
    s_waitcnt vmcnt(2)
L_bc_39:
    s_add_u32 s37, s36, 0xc01000
    buffer_load_dwordx4 v[52:55], v2, s[48:51], s37 offen offset:2048 nt
    v_mov_b32 v8, 1
    s_mov_b64 exec, 1
    ds_add_rtn_u32 v9, v4, v8 offset:60
    s_mov_b64 exec, -1
    s_waitcnt vmcnt(5) lgkmcnt(0)
    v_readfirstlane_b32 s52, v9
    s_nop 0
    s_cmp_gt_i32 s52, 516
    s_cbranch_scc1 L_bc_40
    s_waitcnt vmcnt(2)
L_bc_40:
    s_add_u32 s37, s36, 0xc01000
    buffer_load_dwordx4 v[68:71], v2, s[48:51], s37 offen offset:3072 nt
    v_mov_b32 v8, 1
    s_mov_b64 exec, 1
    ds_add_rtn_u32 v9, v4, v8 offset:60
    s_mov_b64 exec, -1
    s_waitcnt lgkmcnt(0)
    s_and_b32 s37, s35, 4
    s_lshl_b32 s37, s37, 3
    v_mov_b32 v5, s37
    s_cmp_ge_u32 s2, 224
    s_cbranch_scc1 L_wred
    s_bitcmp0_b32 s2, 3
    s_cbranch_scc1 L_fwave
    s_branch L_gffn
L_wred:
    s_cmp_ge_u32 s35, 4
    s_cbranch_scc1 L_fred
    s_waitcnt vmcnt(1)
    v_perm_b32 v104, v44, v40, s32
    v_perm_b32 v105, v52, v48, s32
    v_perm_b32 v106, v60, v56, s32
    v_perm_b32 v108, v44, v40, s33
    v_perm_b32 v109, v52, v48, s33
    v_perm_b32 v110, v60, v56, s33
    v_perm_b32 v112, v45, v41, s32
    v_perm_b32 v113, v53, v49, s32
    v_perm_b32 v114, v61, v57, s32
    v_perm_b32 v116, v45, v41, s33
    v_perm_b32 v117, v53, v49, s33
    v_perm_b32 v118, v61, v57, s33
    v_perm_b32 v120, v46, v42, s32
    v_perm_b32 v121, v54, v50, s32
    v_perm_b32 v122, v62, v58, s32
    v_perm_b32 v124, v46, v42, s33
    v_perm_b32 v125, v54, v50, s33
    v_perm_b32 v126, v62, v58, s33
    v_perm_b32 v128, v47, v43, s32
    v_perm_b32 v129, v55, v51, s32
    v_perm_b32 v130, v63, v59, s32
    v_perm_b32 v132, v47, v43, s33
    v_perm_b32 v133, v55, v51, s33
    v_perm_b32 v134, v63, v59, s33
    s_waitcnt vmcnt(0)
    v_perm_b32 v107, v68, v64, s32
    v_perm_b32 v111, v68, v64, s33
    v_perm_b32 v115, v69, v65, s32
    v_perm_b32 v119, v69, v65, s33
    v_mfma_f32_16x16x32_bf16 v[136:139], v[36:39], v[104:107], v[136:139]
    v_perm_b32 v123, v70, v66, s32
    v_mfma_f32_16x16x32_bf16 v[140:143], v[36:39], v[108:111], v[140:143]
    v_perm_b32 v127, v70, v66, s33
    v_mfma_f32_16x16x32_bf16 v[144:147], v[36:39], v[112:115], v[144:147]
    v_perm_b32 v131, v71, v67, s32
    v_mfma_f32_16x16x32_bf16 v[148:151], v[36:39], v[116:119], v[148:151]
    v_perm_b32 v135, v71, v67, s33
    v_mfma_f32_16x16x32_bf16 v[152:155], v[36:39], v[120:123], v[152:155]
    v_mfma_f32_16x16x32_bf16 v[156:159], v[36:39], v[124:127], v[156:159]
    v_mfma_f32_16x16x32_bf16 v[160:163], v[36:39], v[128:131], v[160:163]
    v_mfma_f32_16x16x32_bf16 v[164:167], v[36:39], v[132:135], v[164:167]
    s_mov_b32 exec_hi, 0
    ds_write_b128 v18, v[136:139] offset:12288
    ds_write_b128 v18, v[140:143] offset:12320
    ds_write_b128 v18, v[144:147] offset:12352
    ds_write_b128 v18, v[148:151] offset:12384
    ds_write_b128 v18, v[152:155] offset:12416
    ds_write_b128 v18, v[156:159] offset:12448
    ds_write_b128 v18, v[160:163] offset:12480
    ds_write_b128 v18, v[164:167] offset:12512
    v_mov_b32 v3, 1
    s_mov_b64 exec, 1
    ds_add_u32 v5, v3 offset:24
    s_mov_b64 exec, -1
    v_perm_b32 v40, v76, v72, s32
    v_perm_b32 v41, v84, v80, s32
    v_perm_b32 v42, v92, v88, s32
    v_perm_b32 v43, v100, v96, s32
    v_perm_b32 v44, v76, v72, s33
    v_perm_b32 v45, v84, v80, s33
    v_perm_b32 v46, v92, v88, s33
    v_perm_b32 v47, v100, v96, s33
    v_perm_b32 v48, v77, v73, s32
    v_perm_b32 v49, v85, v81, s32
    v_perm_b32 v50, v93, v89, s32
    v_perm_b32 v51, v101, v97, s32
    v_perm_b32 v52, v77, v73, s33
    v_perm_b32 v53, v85, v81, s33
    v_perm_b32 v54, v93, v89, s33
    v_perm_b32 v55, v101, v97, s33
    v_perm_b32 v56, v78, v74, s32
    v_perm_b32 v57, v86, v82, s32
    v_perm_b32 v58, v94, v90, s32
    v_perm_b32 v59, v102, v98, s32
    v_perm_b32 v60, v78, v74, s33
    v_perm_b32 v61, v86, v82, s33
    v_perm_b32 v62, v94, v90, s33
    v_perm_b32 v63, v102, v98, s33
    v_perm_b32 v64, v79, v75, s32
    v_perm_b32 v65, v87, v83, s32
    v_perm_b32 v66, v95, v91, s32
    v_perm_b32 v67, v103, v99, s32
    v_perm_b32 v68, v79, v75, s33
    v_perm_b32 v69, v87, v83, s33
    v_perm_b32 v70, v95, v91, s33
    v_perm_b32 v71, v103, v99, s33
    s_mov_b32 s59, 0
L_g_41:
    ds_read_b128 v[12:15], v22 offset:1024
    s_waitcnt lgkmcnt(0)
    v_max_u32 v3, v12, v13
    v_max3_u32 v3, v3, v14, v15
    v_cmp_eq_u32 vcc, -1, v3
    s_cbranch_vccz L_gx_42
    s_add_u32 s59, s59, 1
    s_cmp_lt_u32 s59, 0x800000
    s_cbranch_scc1 L_g_41
L_gx_42:
    s_branch L_ogot
L_gffn:
    v_and_b32 v20, 0xc000, v19
    v_add_u32 v20, v20, v19
    s_xor_b32 s37, s10, s2
    s_xor_b32 s37, s37, s35
    s_and_b32 s37, s37, 4
    s_lshl_b32 s37, s37, 11
    s_add_u32 s45, s45, s37
    s_waitcnt vmcnt(2)
    s_add_u32 s37, s38, 0x0
    buffer_load_dwordx4 v[72:75], v1, s[16:19], s37 offen nt
    s_waitcnt vmcnt(2)
    s_add_u32 s37, s38, 0x40000
    buffer_load_dwordx4 v[76:79], v1, s[16:19], s37 offen nt
    s_waitcnt vmcnt(3)
    v_mov_b32 v3, 1
    s_mov_b64 exec, 1
    ds_add_u32 v4, v3 offset:40
    s_mov_b64 exec, -1
    v_perm_b32 v104, v44, v40, s32
    v_perm_b32 v105, v52, v48, s32
    v_perm_b32 v106, v60, v56, s32
    v_perm_b32 v108, v44, v40, s33
    v_perm_b32 v109, v52, v48, s33
    v_perm_b32 v110, v60, v56, s33
    v_perm_b32 v112, v45, v41, s32
    v_perm_b32 v113, v53, v49, s32
    v_perm_b32 v114, v61, v57, s32
    v_perm_b32 v116, v45, v41, s33
    v_perm_b32 v117, v53, v49, s33
    v_perm_b32 v118, v61, v57, s33
    v_perm_b32 v120, v46, v42, s32
    v_perm_b32 v121, v54, v50, s32
    v_perm_b32 v122, v62, v58, s32
    v_perm_b32 v124, v46, v42, s33
    v_perm_b32 v125, v54, v50, s33
    v_perm_b32 v126, v62, v58, s33
    v_perm_b32 v128, v47, v43, s32
    v_perm_b32 v129, v55, v51, s32
    v_perm_b32 v130, v63, v59, s32
    v_perm_b32 v132, v47, v43, s33
    v_perm_b32 v133, v55, v51, s33
    v_perm_b32 v134, v63, v59, s33
    s_waitcnt vmcnt(2)
    v_perm_b32 v107, v68, v64, s32
    v_perm_b32 v111, v68, v64, s33
    v_perm_b32 v115, v69, v65, s32
    v_perm_b32 v119, v69, v65, s33
    v_mfma_f32_16x16x32_bf16 v[136:139], v[36:39], v[104:107], v[136:139]
    v_perm_b32 v123, v70, v66, s32
    v_mfma_f32_16x16x32_bf16 v[140:143], v[36:39], v[108:111], v[140:143]
    v_perm_b32 v127, v70, v66, s33
    v_mfma_f32_16x16x32_bf16 v[144:147], v[36:39], v[112:115], v[144:147]
    v_perm_b32 v131, v71, v67, s32
    v_mfma_f32_16x16x32_bf16 v[148:151], v[36:39], v[116:119], v[148:151]
    v_perm_b32 v135, v71, v67, s33
    v_mfma_f32_16x16x32_bf16 v[152:155], v[36:39], v[120:123], v[152:155]
    v_mfma_f32_16x16x32_bf16 v[156:159], v[36:39], v[124:127], v[156:159]
    v_mfma_f32_16x16x32_bf16 v[160:163], v[36:39], v[128:131], v[160:163]
    v_mfma_f32_16x16x32_bf16 v[164:167], v[36:39], v[132:135], v[164:167]
    s_mov_b32 exec_hi, 0
    ds_write_b128 v18, v[136:139] offset:12288
    ds_write_b128 v18, v[140:143] offset:12320
    ds_write_b128 v18, v[144:147] offset:12352
    ds_write_b128 v18, v[148:151] offset:12384
    ds_write_b128 v18, v[152:155] offset:12416
    ds_write_b128 v18, v[156:159] offset:12448
    ds_write_b128 v18, v[160:163] offset:12480
    ds_write_b128 v18, v[164:167] offset:12512
    v_mov_b32 v3, 1
    s_mov_b64 exec, 1
    ds_add_u32 v5, v3 offset:24
    s_mov_b64 exec, -1
    ds_read_b32 v3, v4 offset:40
    s_waitcnt lgkmcnt(0)
    v_readfirstlane_b32 s52, v3
    s_waitcnt vmcnt(7)
    s_cmp_ge_u32 s52, 12
    s_cbranch_scc1 L_sb_43
    s_waitcnt vmcnt(2)
    s_mov_b32 s59, 0x4000
L_sg_44:
    ds_read_b32 v3, v4 offset:40
    s_waitcnt lgkmcnt(0)
    v_readfirstlane_b32 s52, v3
    s_nop 0
    s_sub_u32 s52, s52, 8
    s_cmp_ge_u32 s52, 4
    s_cbranch_scc1 L_sgx_45
    s_sub_u32 s59, s59, 1
    s_cbranch_scc0 L_sg_44
L_sgx_45:
L_sb_43:
    s_add_u32 s37, s38, 0x80000
    buffer_load_dwordx4 v[80:83], v1, s[16:19], s37 offen nt
    ds_read_b32 v3, v4 offset:40
    s_waitcnt lgkmcnt(0)
    v_readfirstlane_b32 s52, v3
    s_waitcnt vmcnt(7)
    s_cmp_ge_u32 s52, 12
    s_cbranch_scc1 L_sb_46
    s_waitcnt vmcnt(2)
    s_mov_b32 s59, 0x4000
L_sg_47:
    ds_read_b32 v3, v4 offset:40
    s_waitcnt lgkmcnt(0)
    v_readfirstlane_b32 s52, v3
    s_nop 0
    s_sub_u32 s52, s52, 8
    s_cmp_ge_u32 s52, 4
    s_cbranch_scc1 L_sgx_48
    s_sub_u32 s59, s59, 1
    s_cbranch_scc0 L_sg_47
L_sgx_48:
L_sb_46:
    s_add_u32 s37, s38, 0xc0000
    buffer_load_dwordx4 v[84:87], v1, s[16:19], s37 offen nt
    ds_read_b32 v3, v4 offset:40
    s_waitcnt lgkmcnt(0)
    v_readfirstlane_b32 s52, v3
    s_waitcnt vmcnt(7)
    s_cmp_ge_u32 s52, 12
    s_cbranch_scc1 L_sb_49
    s_waitcnt vmcnt(2)
    s_mov_b32 s59, 0x4000
L_sg_50:
    ds_read_b32 v3, v4 offset:40
    s_waitcnt lgkmcnt(0)
    v_readfirstlane_b32 s52, v3
    s_nop 0
    s_sub_u32 s52, s52, 8
    s_cmp_ge_u32 s52, 4
    s_cbranch_scc1 L_sgx_51
    s_sub_u32 s59, s59, 1
    s_cbranch_scc0 L_sg_50
L_sgx_51:
L_sb_49:
    s_add_u32 s37, s38, 0x100000
    buffer_load_dwordx4 v[88:91], v1, s[16:19], s37 offen nt
    ds_read_b32 v3, v4 offset:40
    s_waitcnt lgkmcnt(0)
    v_readfirstlane_b32 s52, v3
    s_waitcnt vmcnt(7)
    s_cmp_ge_u32 s52, 12
    s_cbranch_scc1 L_sb_52
    s_waitcnt vmcnt(2)
    s_mov_b32 s59, 0x4000
L_sg_53:
    ds_read_b32 v3, v4 offset:40
    s_waitcnt lgkmcnt(0)
    v_readfirstlane_b32 s52, v3
    s_nop 0
    s_sub_u32 s52, s52, 8
    s_cmp_ge_u32 s52, 4
    s_cbranch_scc1 L_sgx_54
    s_sub_u32 s59, s59, 1
    s_cbranch_scc0 L_sg_53
L_sgx_54:
L_sb_52:
    s_add_u32 s37, s38, 0x140000
    buffer_load_dwordx4 v[92:95], v1, s[16:19], s37 offen nt
    ds_read_b32 v3, v4 offset:40
    s_waitcnt lgkmcnt(0)
    v_readfirstlane_b32 s52, v3
    s_waitcnt vmcnt(7)
    s_cmp_ge_u32 s52, 12
    s_cbranch_scc1 L_sb_55
    s_waitcnt vmcnt(2)
    s_mov_b32 s59, 0x4000
L_sg_56:
    ds_read_b32 v3, v4 offset:40
    s_waitcnt lgkmcnt(0)
    v_readfirstlane_b32 s52, v3
    s_nop 0
    s_sub_u32 s52, s52, 8
    s_cmp_ge_u32 s52, 4
    s_cbranch_scc1 L_sgx_57
    s_sub_u32 s59, s59, 1
    s_cbranch_scc0 L_sg_56
L_sgx_57:
L_sb_55:
    s_add_u32 s37, s38, 0x180000
    buffer_load_dwordx4 v[96:99], v1, s[16:19], s37 offen nt
    ds_read_b32 v3, v4 offset:40
    s_waitcnt lgkmcnt(0)
    v_readfirstlane_b32 s52, v3
    s_waitcnt vmcnt(7)
    s_cmp_ge_u32 s52, 12
    s_cbranch_scc1 L_sb_58
    s_waitcnt vmcnt(2)
    s_mov_b32 s59, 0x4000
L_sg_59:
    ds_read_b32 v3, v4 offset:40
    s_waitcnt lgkmcnt(0)
    v_readfirstlane_b32 s52, v3
    s_nop 0
    s_sub_u32 s52, s52, 8
    s_cmp_ge_u32 s52, 4
    s_cbranch_scc1 L_sgx_60
    s_sub_u32 s59, s59, 1
    s_cbranch_scc0 L_sg_59
L_sgx_60:
L_sb_58:
    s_add_u32 s37, s38, 0x1c0000
    buffer_load_dwordx4 v[100:103], v1, s[16:19], s37 offen nt
    s_waitcnt vmcnt(0)
    v_perm_b32 v40, v76, v72, s32
    v_perm_b32 v41, v84, v80, s32
    v_perm_b32 v42, v92, v88, s32
    v_perm_b32 v43, v100, v96, s32
    v_perm_b32 v44, v76, v72, s33
    v_perm_b32 v45, v84, v80, s33
    v_perm_b32 v46, v92, v88, s33
    v_perm_b32 v47, v100, v96, s33
    v_perm_b32 v48, v77, v73, s32
    v_perm_b32 v49, v85, v81, s32
    v_perm_b32 v50, v93, v89, s32
    v_perm_b32 v51, v101, v97, s32
    v_perm_b32 v52, v77, v73, s33
    v_perm_b32 v53, v85, v81, s33
    v_perm_b32 v54, v93, v89, s33
    v_perm_b32 v55, v101, v97, s33
    v_perm_b32 v56, v78, v74, s32
    v_perm_b32 v57, v86, v82, s32
    v_perm_b32 v58, v94, v90, s32
    v_perm_b32 v59, v102, v98, s32
    v_perm_b32 v60, v78, v74, s33
    v_perm_b32 v61, v86, v82, s33
    v_perm_b32 v62, v94, v90, s33
    v_perm_b32 v63, v102, v98, s33
    v_perm_b32 v64, v79, v75, s32
    v_perm_b32 v65, v87, v83, s32
    v_perm_b32 v66, v95, v91, s32
    v_perm_b32 v67, v103, v99, s32
    v_perm_b32 v68, v79, v75, s33
    v_perm_b32 v69, v87, v83, s33
    v_perm_b32 v70, v95, v91, s33
    v_perm_b32 v71, v103, v99, s33
    s_mov_b32 s59, 0
L_g_61:
    ds_read_b128 v[12:15], v22 offset:1024
    s_waitcnt lgkmcnt(0)
    v_max_u32 v3, v12, v13
    v_max3_u32 v3, v3, v14, v15
    v_cmp_eq_u32 vcc, -1, v3
    s_cbranch_vccz L_gx_62
    s_add_u32 s59, s59, 1
    s_cmp_lt_u32 s59, 0x800000
    s_cbranch_scc1 L_g_61
L_gx_62:
L_ogot:
    v_mfma_f32_16x16x32_bf16 v[72:75], v[12:15], v[40:43], 0
    v_mfma_f32_16x16x32_bf16 v[76:79], v[12:15], v[44:47], 0
    v_mfma_f32_16x16x32_bf16 v[80:83], v[12:15], v[48:51], 0
    v_mfma_f32_16x16x32_bf16 v[84:87], v[12:15], v[52:55], 0
    v_mfma_f32_16x16x32_bf16 v[88:91], v[12:15], v[56:59], 0
    v_mfma_f32_16x16x32_bf16 v[92:95], v[12:15], v[60:63], 0
    v_mfma_f32_16x16x32_bf16 v[96:99], v[12:15], v[64:67], 0
    v_mfma_f32_16x16x32_bf16 v[100:103], v[12:15], v[68:71], 0
    s_nop 4
    v_mov_b32_dpp v72, v88 quad_perm:[0,1,2,3] row_mask:0x2 bank_mask:0xf
    s_nop 1
    v_mov_b32_dpp v84, v100 quad_perm:[0,1,2,3] row_mask:0x2 bank_mask:0xf
    v_mov_b32 v9, v76
    v_mov_b32 v10, v80
    v_bfi_b32 v8, 15, s8, v72
    v_bfi_b32 v11, 15, s9, v84
    v_mov_b32_dpp v9, v92 quad_perm:[0,1,2,3] row_mask:0x2 bank_mask:0xf
    v_mov_b32_dpp v10, v96 quad_perm:[0,1,2,3] row_mask:0x2 bank_mask:0xf
    s_mov_b32 exec_hi, 0
    s_bitcmp0_b32 s10, 1
    s_cbranch_scc1 L_ps_63
    buffer_store_dwordx4 v[8:11], v19, s[12:15], s44 offen
L_pb_64:
    s_mov_b64 exec, -1
    s_cmp_ge_u32 s2, 224
    s_cbranch_scc1 L_gdone
    v_mov_b32 v3, 1
    s_mov_b64 exec, 1
    ds_add_u32 v4, v3 offset:12
    s_mov_b64 exec, -1
    s_mov_b32 s59, 0
L_sp_65:
    ds_read_b32 v3, v4 offset:12
    s_waitcnt lgkmcnt(0)
    v_cmp_gt_u32 vcc, 12, v3
    s_cbranch_vccz L_spx_66
    s_add_u32 s59, s59, 1
    s_cmp_lt_u32 s59, 0x800000
    s_cbranch_scc1 L_sp_65
L_spx_66:
    s_waitcnt vmcnt(7)
    s_add_u32 s37, s41, 0x0
    buffer_load_dwordx4 v[104:107], v17, s[28:31], s37 offen nt
    s_waitcnt vmcnt(7)
    s_add_u32 s37, s41, 0x800
    buffer_load_dwordx4 v[108:111], v17, s[28:31], s37 offen nt
    s_waitcnt vmcnt(7)
    s_add_u32 s37, s41, 0x1000
    buffer_load_dwordx4 v[112:115], v17, s[28:31], s37 offen nt
    s_waitcnt vmcnt(7)
    s_add_u32 s37, s41, 0x1800
    buffer_load_dwordx4 v[116:119], v17, s[28:31], s37 offen nt
    s_waitcnt vmcnt(7)
    s_add_u32 s37, s41, 0x2000
    buffer_load_dwordx4 v[120:123], v17, s[28:31], s37 offen nt
    s_waitcnt vmcnt(7)
    s_add_u32 s37, s41, 0x2800
    buffer_load_dwordx4 v[124:127], v17, s[28:31], s37 offen nt
    s_waitcnt vmcnt(7)
    s_add_u32 s37, s41, 0x3000
    buffer_load_dwordx4 v[128:131], v17, s[28:31], s37 offen nt
    s_waitcnt vmcnt(7)
    s_add_u32 s37, s41, 0x3800
    buffer_load_dwordx4 v[132:135], v17, s[28:31], s37 offen nt
    v_mov_b32 v3, 1
    s_mov_b64 exec, 1
    ds_add_u32 v4, v3 offset:32
    s_mov_b64 exec, -1
    s_waitcnt vmcnt(0)
    v_perm_b32 v40, v108, v104, s32
    v_perm_b32 v41, v116, v112, s32
    v_perm_b32 v42, v124, v120, s32
    v_perm_b32 v43, v132, v128, s32
    v_perm_b32 v44, v108, v104, s33
    v_perm_b32 v45, v116, v112, s33
    v_perm_b32 v46, v124, v120, s33
    v_perm_b32 v47, v132, v128, s33
    v_perm_b32 v48, v109, v105, s32
    v_perm_b32 v49, v117, v113, s32
    v_perm_b32 v50, v125, v121, s32
    v_perm_b32 v51, v133, v129, s32
    v_perm_b32 v52, v109, v105, s33
    v_perm_b32 v53, v117, v113, s33
    v_perm_b32 v54, v125, v121, s33
    v_perm_b32 v55, v133, v129, s33
    v_perm_b32 v56, v110, v106, s32
    v_perm_b32 v57, v118, v114, s32
    v_perm_b32 v58, v126, v122, s32
    v_perm_b32 v59, v134, v130, s32
    v_perm_b32 v60, v110, v106, s33
    v_perm_b32 v61, v118, v114, s33
    v_perm_b32 v62, v126, v122, s33
    v_perm_b32 v63, v134, v130, s33
    v_perm_b32 v64, v111, v107, s32
    v_perm_b32 v65, v119, v115, s32
    v_perm_b32 v66, v127, v123, s32
    v_perm_b32 v67, v135, v131, s32
    v_perm_b32 v68, v111, v107, s33
    v_perm_b32 v69, v119, v115, s33
    v_perm_b32 v70, v127, v123, s33
    v_perm_b32 v71, v135, v131, s33
    s_mov_b32 s59, 0
L_g_67:
    ds_read_b128 v[12:15], v21 offset:1536
    s_waitcnt lgkmcnt(0)
    v_max_u32 v3, v12, v13
    v_max3_u32 v3, v3, v14, v15
    v_cmp_eq_u32 vcc, -1, v3
    s_cbranch_vccz L_gx_68
    s_sleep 1
    s_add_u32 s59, s59, 1
    s_cmp_lt_u32 s59, 0x800000
    s_cbranch_scc1 L_g_67
L_gx_68:
    v_mfma_f32_16x16x32_bf16 v[72:75], v[12:15], v[40:43], 0
    v_mfma_f32_16x16x32_bf16 v[76:79], v[12:15], v[44:47], 0
    v_mfma_f32_16x16x32_bf16 v[80:83], v[12:15], v[48:51], 0
    v_mfma_f32_16x16x32_bf16 v[84:87], v[12:15], v[52:55], 0
    v_mfma_f32_16x16x32_bf16 v[88:91], v[12:15], v[56:59], 0
    v_mfma_f32_16x16x32_bf16 v[92:95], v[12:15], v[60:63], 0
    v_mfma_f32_16x16x32_bf16 v[96:99], v[12:15], v[64:67], 0
    v_mfma_f32_16x16x32_bf16 v[100:103], v[12:15], v[68:71], 0
    s_nop 4
    v_mov_b32_dpp v72, v88 quad_perm:[0,1,2,3] row_mask:0x2 bank_mask:0xf
    s_nop 1
    v_mov_b32_dpp v84, v100 quad_perm:[0,1,2,3] row_mask:0x2 bank_mask:0xf
    v_mov_b32 v9, v76
    v_mov_b32 v10, v80
    v_bfi_b32 v8, 15, s8, v72
    v_bfi_b32 v11, 15, s9, v84
    v_mov_b32_dpp v9, v92 quad_perm:[0,1,2,3] row_mask:0x2 bank_mask:0xf
    v_mov_b32_dpp v10, v96 quad_perm:[0,1,2,3] row_mask:0x2 bank_mask:0xf
    s_mov_b32 exec_hi, 0
    buffer_store_dwordx4 v[8:11], v20, s[12:15], s45 offen sc1
    s_xor_b32 s45, s45, 0x2000
    buffer_store_dwordx4 v[8:11], v20, s[12:15], s45 offen sc1
    s_mov_b64 exec, -1
L_gdone:
    s_branch L_wdone
L_opoll:
    s_waitcnt lgkmcnt(0)
    s_lshr_b32 s42, s2, 3
    s_lshl_b32 s42, s42, 2
    s_and_b32 s37, s3, 3
    s_add_u32 s42, s42, s37
    s_lshl_b32 s42, s42, 8
    s_add_u32 s42, s42, 0xb6000
    s_bfe_u32 s43, s10, 0x10002
    s_lshl_b32 s43, s43, 13
    s_add_u32 s42, s42, s43
    s_lshl_b32 s37, s37, 6
    v_and_b32 v32, 0x30, v0
    v_add_u32 v32, s37, v32
    s_mov_b32 s44, s51
    s_mov_b32 s45, s56
    s_mov_b32 s43, 0x400000
L_p1:
    s_load_dwordx16 s[64:79], s[12:13], s42 offset:0 glc
    s_load_dwordx16 s[80:95], s[12:13], s42 offset:64 glc
    s_load_dwordx16 s[16:31], s[12:13], s42 offset:128 glc
    s_load_dwordx16 s[48:63], s[12:13], s42 offset:192 glc
    s_waitcnt lgkmcnt(0)
    s_max_u32 s37, s16, s48
    s_cmp_lg_u32 s37, -1
    s_cbranch_scc1 L_pB
    s_max_u32 s37, s64, s80
    s_cmp_lg_u32 s37, -1
    s_cbranch_scc1 L_pA
L_p1r:
    s_sleep 1
    s_sub_u32 s43, s43, 1
    s_cbranch_scc0 L_p1
    s_branch L_padd
L_pA:
    v_mov_b64 v[24:25], s[64:65]
    v_mov_b64 v[26:27], s[66:67]
    v_mov_b64 v[28:29], s[68:69]
    v_mov_b64 v[30:31], s[70:71]
    s_mov_b32 exec_lo, 0xffff0000
    v_mov_b64 v[24:25], s[72:73]
    v_mov_b64 v[26:27], s[74:75]
    v_mov_b64 v[28:29], s[76:77]
    v_mov_b64 v[30:31], s[78:79]
    s_mov_b32 exec_lo, 0
    v_mov_b64 v[24:25], s[80:81]
    v_mov_b64 v[26:27], s[82:83]
    v_mov_b64 v[28:29], s[84:85]
    v_mov_b64 v[30:31], s[86:87]
    s_mov_b32 exec_hi, 0xffff0000
    v_mov_b64 v[24:25], s[88:89]
    v_mov_b64 v[26:27], s[90:91]
    v_mov_b64 v[28:29], s[92:93]
    v_mov_b64 v[30:31], s[94:95]
    s_mov_b64 exec, -1
    v_max_u32 v33, v24, v25
    v_max3_u32 v33, v33, v26, v27
    v_max3_u32 v33, v33, v28, v29
    v_max3_u32 v33, v33, v30, v31
    v_cmp_eq_u32 vcc, -1, v33
    s_cbranch_vccnz L_p1r
    s_add_u32 s42, s42, 128
    s_branch L_p2
L_pB:
    v_mov_b64 v[24:25], s[16:17]
    v_mov_b64 v[26:27], s[18:19]
    v_mov_b64 v[28:29], s[20:21]
    v_mov_b64 v[30:31], s[22:23]
    s_mov_b32 exec_lo, 0xffff0000
    v_mov_b64 v[24:25], s[24:25]
    v_mov_b64 v[26:27], s[26:27]
    v_mov_b64 v[28:29], s[28:29]
    v_mov_b64 v[30:31], s[30:31]
    s_mov_b32 exec_lo, 0
    v_mov_b64 v[24:25], s[48:49]
    v_mov_b64 v[26:27], s[50:51]
    v_mov_b64 v[28:29], s[52:53]
    v_mov_b64 v[30:31], s[54:55]
    s_mov_b32 exec_hi, 0xffff0000
    v_mov_b64 v[24:25], s[56:57]
    v_mov_b64 v[26:27], s[58:59]
    v_mov_b64 v[28:29], s[60:61]
    v_mov_b64 v[30:31], s[62:63]
    s_mov_b64 exec, -1
    v_max_u32 v33, v24, v25
    v_max3_u32 v33, v33, v26, v27
    v_max3_u32 v33, v33, v28, v29
    v_max3_u32 v33, v33, v30, v31
    v_cmp_eq_u32 vcc, -1, v33
    s_cbranch_vccnz L_p1r
    s_branch L_p2c
L_p2:
    s_load_dwordx16 s[64:79], s[12:13], s42 offset:0 glc
    s_load_dwordx16 s[80:95], s[12:13], s42 offset:64 glc
    s_waitcnt lgkmcnt(0)
L_p2c:
    s_max_u32 s37, s64, s80
    s_cmp_lg_u32 s37, -1
    s_cbranch_scc1 L_padd
L_p2r:
    s_sub_u32 s43, s43, 1
    s_cbranch_scc0 L_p2
L_padd:
    v_pk_add_f32 v[40:41], v[24:25], s[64:65]
    v_pk_add_f32 v[42:43], v[26:27], s[66:67]
    v_pk_add_f32 v[44:45], v[28:29], s[68:69]
    v_pk_add_f32 v[46:47], v[30:31], s[70:71]
    s_mov_b32 exec_lo, 0xffff0000
    v_pk_add_f32 v[40:41], v[24:25], s[72:73]
    v_pk_add_f32 v[42:43], v[26:27], s[74:75]
    v_pk_add_f32 v[44:45], v[28:29], s[76:77]
    v_pk_add_f32 v[46:47], v[30:31], s[78:79]
    s_mov_b32 exec_lo, 0
    v_pk_add_f32 v[40:41], v[24:25], s[80:81]
    v_pk_add_f32 v[42:43], v[26:27], s[82:83]
    v_pk_add_f32 v[44:45], v[28:29], s[84:85]
    v_pk_add_f32 v[46:47], v[30:31], s[86:87]
    s_mov_b32 exec_hi, 0xffff0000
    v_pk_add_f32 v[40:41], v[24:25], s[88:89]
    v_pk_add_f32 v[42:43], v[26:27], s[90:91]
    v_pk_add_f32 v[44:45], v[28:29], s[92:93]
    v_pk_add_f32 v[46:47], v[30:31], s[94:95]
    s_mov_b64 exec, -1
    v_pk_add_f32 v[48:49], v[40:41], v[42:43]
    v_pk_add_f32 v[50:51], v[44:45], v[46:47]
    v_cvt_pk_bf16_f32 v52, v40, v41
    v_cvt_pk_bf16_f32 v53, v42, v43
    v_cvt_pk_bf16_f32 v54, v44, v45
    v_cvt_pk_bf16_f32 v55, v46, v47
    v_pk_add_f32 v[48:49], v[48:49], v[50:51]
    v_min_u32 v52, -2, v52
    v_min_u32 v53, -2, v53
    v_min_u32 v54, -2, v54
    v_min_u32 v55, -2, v55
    v_cmp_u_f32 vcc, v48, v49
    s_cbranch_vccnz L_pnan
L_pok:
    ds_write_b128 v32, v[52:55] offset:1024
    s_endpgm
L_pnan:
    s_mov_b32 s37, 0
    s_max_u32 s37, s37, s64
    s_max_u32 s37, s37, s65
    s_max_u32 s37, s37, s66
    s_max_u32 s37, s37, s67
    s_max_u32 s37, s37, s68
    s_max_u32 s37, s37, s69
    s_max_u32 s37, s37, s70
    s_max_u32 s37, s37, s71
    s_max_u32 s37, s37, s72
    s_max_u32 s37, s37, s73
    s_max_u32 s37, s37, s74
    s_max_u32 s37, s37, s75
    s_max_u32 s37, s37, s76
    s_max_u32 s37, s37, s77
    s_max_u32 s37, s37, s78
    s_max_u32 s37, s37, s79
    s_max_u32 s37, s37, s80
    s_max_u32 s37, s37, s81
    s_max_u32 s37, s37, s82
    s_max_u32 s37, s37, s83
    s_max_u32 s37, s37, s84
    s_max_u32 s37, s37, s85
    s_max_u32 s37, s37, s86
    s_max_u32 s37, s37, s87
    s_max_u32 s37, s37, s88
    s_max_u32 s37, s37, s89
    s_max_u32 s37, s37, s90
    s_max_u32 s37, s37, s91
    s_max_u32 s37, s37, s92
    s_max_u32 s37, s37, s93
    s_max_u32 s37, s37, s94
    s_max_u32 s37, s37, s95
    s_cmp_lg_u32 s37, -1
    s_cbranch_scc1 L_pok
    s_cmp_lt_i32 s43, 0
    s_cbranch_scc1 L_pok
    s_branch L_p2r
L_fwave:
    v_mov_b32 v16, s20
    v_mov_b32 v17, s21
    v_mov_b32 v1, s22
    v_mov_b32 v3, s23
    s_nop 0
    v_mov_b32_dpp v16, v1 quad_perm:[0,1,2,3] row_mask:0xf bank_mask:0xc
    v_mov_b32_dpp v17, v3 quad_perm:[0,1,2,3] row_mask:0xf bank_mask:0xc
    v_lshrrev_b32 v6, 4, v0
    v_mul_u32_u24 v6, 57344, v6
    v_and_b32 v3, 7, v0
    v_lshl_add_u32 v6, v3, 4, v6
    s_lshr_b32 s43, s2, 4
    s_lshl_b32 s43, s43, 3
    s_mul_i32 s47, s43, 147
    s_lshr_b32 s47, s47, 10
    s_add_u32 s43, s43, s35
    s_mul_i32 s42, s43, 147
    s_lshr_b32 s42, s42, 10
    s_and_b32 s46, s2, 7
    s_sub_u32 s46, s46, s42
    s_mul_i32 s46, s46, 7
    s_add_u32 s46, s46, s43
    s_sub_u32 s47, s42, s47
    s_lshl_b32 s47, s47, 7
    s_lshl_b32 s44, s42, 8
    s_and_b32 s41, s10, 4
    s_lshl_b32 s41, s41, 11
    s_add_u32 s41, s41, s44
    s_add_u32 s41, s41, 0xa9000
    v_bfe_u32 v1, v0, 2, 1
    v_lshl_add_u32 v22, v1, 6, v21
    s_lshl_b32 s47, s47, 1
    v_add_u32 v22, s47, v22
    s_mul_i32 s42, s42, 458752
    s_mov_b32 s43, s46
    s_lshl_b32 s45, s43, 13
    s_add_u32 s44, s44, s45
    s_and_b32 s45, s2, 7
    s_lshl_b32 s45, s45, 13
    s_add_u32 s44, s44, s45
    s_xor_b32 s8, s8, 8
    s_xor_b32 s9, s9, 8
    s_add_u32 s44, s44, 0x200000
    s_lshl_b32 s43, s43, 7
    s_add_u32 s42, s42, s43
    v_add_u32 v6, s42, v6
    v_mov_b32 v7, 0
    v_lshl_add_u64 v[16:17], v[16:17], 0, v[6:7]
    s_mov_b32 s43, 0
    s_waitcnt vmcnt(5)
    s_mov_b32 s42, 0
    v_lshl_add_u64 v[6:7], v[16:17], 0, s[42:43]
    global_load_dwordx4 v[72:75], v[6:7], off nt
    s_waitcnt vmcnt(5)
    s_mov_b32 s42, 7168
    v_lshl_add_u64 v[6:7], v[16:17], 0, s[42:43]
    global_load_dwordx4 v[76:79], v[6:7], off nt
    s_waitcnt vmcnt(3)
    v_mov_b32 v3, 1
    s_mov_b64 exec, 1
    ds_add_u32 v4, v3 offset:40
    s_mov_b64 exec, -1
    v_perm_b32 v104, v44, v40, s32
    v_perm_b32 v105, v52, v48, s32
    v_perm_b32 v106, v60, v56, s32
    v_perm_b32 v108, v44, v40, s33
    v_perm_b32 v109, v52, v48, s33
    v_perm_b32 v110, v60, v56, s33
    v_perm_b32 v112, v45, v41, s32
    v_perm_b32 v113, v53, v49, s32
    v_perm_b32 v114, v61, v57, s32
    v_perm_b32 v116, v45, v41, s33
    v_perm_b32 v117, v53, v49, s33
    v_perm_b32 v118, v61, v57, s33
    v_perm_b32 v120, v46, v42, s32
    v_perm_b32 v121, v54, v50, s32
    v_perm_b32 v122, v62, v58, s32
    v_perm_b32 v124, v46, v42, s33
    v_perm_b32 v125, v54, v50, s33
    v_perm_b32 v126, v62, v58, s33
    v_perm_b32 v128, v47, v43, s32
    v_perm_b32 v129, v55, v51, s32
    v_perm_b32 v130, v63, v59, s32
    v_perm_b32 v132, v47, v43, s33
    v_perm_b32 v133, v55, v51, s33
    v_perm_b32 v134, v63, v59, s33
    s_waitcnt vmcnt(2)
    v_perm_b32 v107, v68, v64, s32
    v_perm_b32 v111, v68, v64, s33
    v_perm_b32 v115, v69, v65, s32
    v_perm_b32 v119, v69, v65, s33
    v_mfma_f32_16x16x32_bf16 v[136:139], v[36:39], v[104:107], v[136:139]
    v_perm_b32 v123, v70, v66, s32
    v_mfma_f32_16x16x32_bf16 v[140:143], v[36:39], v[108:111], v[140:143]
    v_perm_b32 v127, v70, v66, s33
    v_mfma_f32_16x16x32_bf16 v[144:147], v[36:39], v[112:115], v[144:147]
    v_perm_b32 v131, v71, v67, s32
    v_mfma_f32_16x16x32_bf16 v[148:151], v[36:39], v[116:119], v[148:151]
    v_perm_b32 v135, v71, v67, s33
    v_mfma_f32_16x16x32_bf16 v[152:155], v[36:39], v[120:123], v[152:155]
    v_mfma_f32_16x16x32_bf16 v[156:159], v[36:39], v[124:127], v[156:159]
    v_mfma_f32_16x16x32_bf16 v[160:163], v[36:39], v[128:131], v[160:163]
    v_mfma_f32_16x16x32_bf16 v[164:167], v[36:39], v[132:135], v[164:167]
    s_mov_b32 exec_hi, 0
    ds_write_b128 v18, v[136:139] offset:12288
    ds_write_b128 v18, v[140:143] offset:12320
    ds_write_b128 v18, v[144:147] offset:12352
    ds_write_b128 v18, v[148:151] offset:12384
    ds_write_b128 v18, v[152:155] offset:12416
    ds_write_b128 v18, v[156:159] offset:12448
    ds_write_b128 v18, v[160:163] offset:12480
    ds_write_b128 v18, v[164:167] offset:12512
    v_mov_b32 v3, 1
    s_mov_b64 exec, 1
    ds_add_u32 v5, v3 offset:24
    s_mov_b64 exec, -1
    s_mov_b32 s59, 0x4000
L_sg_69:
    ds_read_b32 v3, v4 offset:40
    s_waitcnt lgkmcnt(0)
    v_readfirstlane_b32 s52, v3
    s_nop 0
    s_sub_u32 s52, s52, 8
    s_cmp_ge_u32 s52, 4
    s_cbranch_scc1 L_sgx_70
    s_sub_u32 s59, s59, 1
    s_cbranch_scc0 L_sg_69
L_sgx_70:
    s_mov_b32 s42, 14336
    v_lshl_add_u64 v[6:7], v[16:17], 0, s[42:43]
    global_load_dwordx4 v[80:83], v[6:7], off nt
    s_waitcnt vmcnt(5)
    s_mov_b32 s59, 0x4000
L_sg_71:
    ds_read_b32 v3, v4 offset:40
    s_waitcnt lgkmcnt(0)
    v_readfirstlane_b32 s52, v3
    s_nop 0
    s_sub_u32 s52, s52, 8
    s_cmp_ge_u32 s52, 4
    s_cbranch_scc1 L_sgx_72
    s_sub_u32 s59, s59, 1
    s_cbranch_scc0 L_sg_71
L_sgx_72:
    s_mov_b32 s42, 21504
    v_lshl_add_u64 v[6:7], v[16:17], 0, s[42:43]
    global_load_dwordx4 v[84:87], v[6:7], off nt
    s_waitcnt vmcnt(5)
    s_mov_b32 s59, 0x4000
L_sg_73:
    ds_read_b32 v3, v4 offset:40
    s_waitcnt lgkmcnt(0)
    v_readfirstlane_b32 s52, v3
    s_nop 0
    s_sub_u32 s52, s52, 8
    s_cmp_ge_u32 s52, 4
    s_cbranch_scc1 L_sgx_74
    s_sub_u32 s59, s59, 1
    s_cbranch_scc0 L_sg_73
L_sgx_74:
    s_mov_b32 s42, 28672
    v_lshl_add_u64 v[6:7], v[16:17], 0, s[42:43]
    global_load_dwordx4 v[88:91], v[6:7], off nt
    s_waitcnt vmcnt(5)
    s_mov_b32 s59, 0x4000
L_sg_75:
    ds_read_b32 v3, v4 offset:40
    s_waitcnt lgkmcnt(0)
    v_readfirstlane_b32 s52, v3
    s_nop 0
    s_sub_u32 s52, s52, 8
    s_cmp_ge_u32 s52, 4
    s_cbranch_scc1 L_sgx_76
    s_sub_u32 s59, s59, 1
    s_cbranch_scc0 L_sg_75
L_sgx_76:
    s_mov_b32 s42, 35840
    v_lshl_add_u64 v[6:7], v[16:17], 0, s[42:43]
    global_load_dwordx4 v[92:95], v[6:7], off nt
    s_waitcnt vmcnt(5)
    s_mov_b32 s59, 0x4000
L_sg_77:
    ds_read_b32 v3, v4 offset:40
    s_waitcnt lgkmcnt(0)
    v_readfirstlane_b32 s52, v3
    s_nop 0
    s_sub_u32 s52, s52, 8
    s_cmp_ge_u32 s52, 4
    s_cbranch_scc1 L_sgx_78
    s_sub_u32 s59, s59, 1
    s_cbranch_scc0 L_sg_77
L_sgx_78:
    s_mov_b32 s42, 43008
    v_lshl_add_u64 v[6:7], v[16:17], 0, s[42:43]
    global_load_dwordx4 v[96:99], v[6:7], off nt
    s_waitcnt vmcnt(5)
    s_mov_b32 s59, 0x4000
L_sg_79:
    ds_read_b32 v3, v4 offset:40
    s_waitcnt lgkmcnt(0)
    v_readfirstlane_b32 s52, v3
    s_nop 0
    s_sub_u32 s52, s52, 8
    s_cmp_ge_u32 s52, 4
    s_cbranch_scc1 L_sgx_80
    s_sub_u32 s59, s59, 1
    s_cbranch_scc0 L_sg_79
L_sgx_80:
    s_mov_b32 s42, 50176
    v_lshl_add_u64 v[6:7], v[16:17], 0, s[42:43]
    global_load_dwordx4 v[100:103], v[6:7], off nt
    s_waitcnt vmcnt(5)
    s_mov_b32 s42, 229376
    v_lshl_add_u64 v[6:7], v[16:17], 0, s[42:43]
    global_load_dwordx4 v[104:107], v[6:7], off nt
    s_waitcnt vmcnt(5)
    s_mov_b32 s42, 236544
    v_lshl_add_u64 v[6:7], v[16:17], 0, s[42:43]
    global_load_dwordx4 v[108:111], v[6:7], off nt
    s_waitcnt vmcnt(5)
    s_mov_b32 s42, 243712
    v_lshl_add_u64 v[6:7], v[16:17], 0, s[42:43]
    global_load_dwordx4 v[112:115], v[6:7], off nt
    s_waitcnt vmcnt(5)
    s_mov_b32 s42, 250880
    v_lshl_add_u64 v[6:7], v[16:17], 0, s[42:43]
    global_load_dwordx4 v[116:119], v[6:7], off nt
    s_waitcnt vmcnt(5)
    s_mov_b32 s42, 258048
    v_lshl_add_u64 v[6:7], v[16:17], 0, s[42:43]
    global_load_dwordx4 v[120:123], v[6:7], off nt
    s_waitcnt vmcnt(5)
    s_mov_b32 s42, 265216
    v_lshl_add_u64 v[6:7], v[16:17], 0, s[42:43]
    global_load_dwordx4 v[124:127], v[6:7], off nt
    s_waitcnt vmcnt(5)
    s_mov_b32 s42, 272384
    v_lshl_add_u64 v[6:7], v[16:17], 0, s[42:43]
    global_load_dwordx4 v[128:131], v[6:7], off nt
    s_waitcnt vmcnt(5)
    s_mov_b32 s42, 279552
    v_lshl_add_u64 v[6:7], v[16:17], 0, s[42:43]
    global_load_dwordx4 v[132:135], v[6:7], off nt
    v_mov_b32 v3, 1
    s_mov_b64 exec, 1
    ds_add_u32 v4, v3 offset:32
    s_mov_b64 exec, -1
    s_mov_b32 s59, 0
L_sp_81:
    ds_read_b32 v3, v4 offset:48
    s_waitcnt lgkmcnt(0)
    v_cmp_gt_u32 vcc, 1, v3
    s_cbranch_vccz L_spx_82
    s_sleep 1
    s_add_u32 s59, s59, 1
    s_cmp_lt_u32 s59, 0x800000
    s_cbranch_scc1 L_sp_81
L_spx_82:
    v_bfe_u32 v1, v0, 3, 1
    v_lshl_add_u32 v22, v1, 9, v22
    v_lshrrev_b32 v23, 2, v21
    v_lshrrev_b32 v1, 5, v0
    v_mul_u32_u24 v3, 24, v1
    v_sub_u32 v20, v20, v3
    v_mul_u32_u24 v25, 15, v1
    v_xor_b32 v24, 15, v25
    s_waitcnt vmcnt(8)
    v_perm_b32 v40, v76, v72, s32
    v_perm_b32 v41, v84, v80, s32
    v_perm_b32 v42, v92, v88, s32
    v_perm_b32 v43, v100, v96, s32
    v_perm_b32 v44, v76, v72, s33
    v_perm_b32 v45, v84, v80, s33
    v_perm_b32 v46, v92, v88, s33
    v_perm_b32 v47, v100, v96, s33
    v_perm_b32 v48, v77, v73, s32
    v_perm_b32 v49, v85, v81, s32
    v_perm_b32 v50, v93, v89, s32
    v_perm_b32 v51, v101, v97, s32
    v_perm_b32 v52, v77, v73, s33
    v_perm_b32 v53, v85, v81, s33
    v_perm_b32 v54, v93, v89, s33
    v_perm_b32 v55, v101, v97, s33
    v_perm_b32 v56, v78, v74, s32
    v_perm_b32 v57, v86, v82, s32
    v_perm_b32 v58, v94, v90, s32
    v_perm_b32 v59, v102, v98, s32
    v_perm_b32 v60, v78, v74, s33
    v_perm_b32 v61, v86, v82, s33
    v_perm_b32 v62, v94, v90, s33
    v_perm_b32 v63, v102, v98, s33
    v_perm_b32 v64, v79, v75, s32
    v_perm_b32 v65, v87, v83, s32
    v_perm_b32 v66, v95, v91, s32
    v_perm_b32 v67, v103, v99, s32
    v_perm_b32 v68, v79, v75, s33
    v_perm_b32 v69, v87, v83, s33
    v_perm_b32 v70, v95, v91, s33
    v_perm_b32 v71, v103, v99, s33
    s_waitcnt vmcnt(4)
    v_perm_b32 v136, v108, v104, s32
    v_perm_b32 v137, v116, v112, s32
    v_perm_b32 v140, v108, v104, s33
    v_perm_b32 v141, v116, v112, s33
    v_perm_b32 v144, v109, v105, s32
    v_perm_b32 v145, v117, v113, s32
    v_perm_b32 v148, v109, v105, s33
    v_perm_b32 v149, v117, v113, s33
    v_perm_b32 v152, v110, v106, s32
    v_perm_b32 v153, v118, v114, s32
    v_perm_b32 v156, v110, v106, s33
    v_perm_b32 v157, v118, v114, s33
    v_perm_b32 v160, v111, v107, s32
    v_perm_b32 v161, v119, v115, s32
    v_perm_b32 v164, v111, v107, s33
    v_perm_b32 v165, v119, v115, s33
    s_waitcnt vmcnt(2)
    v_perm_b32 v138, v124, v120, s32
    v_perm_b32 v142, v124, v120, s33
    v_perm_b32 v146, v125, v121, s32
    v_perm_b32 v150, v125, v121, s33
    v_perm_b32 v154, v126, v122, s32
    v_perm_b32 v158, v126, v122, s33
    v_perm_b32 v162, v127, v123, s32
    v_perm_b32 v166, v127, v123, s33
    s_waitcnt vmcnt(0)
    v_perm_b32 v139, v132, v128, s32
    v_perm_b32 v143, v132, v128, s33
    v_perm_b32 v147, v133, v129, s32
    v_perm_b32 v151, v133, v129, s33
    v_perm_b32 v155, v134, v130, s32
    v_perm_b32 v159, v134, v130, s33
    v_perm_b32 v163, v135, v131, s32
    v_perm_b32 v167, v135, v131, s33
    s_mov_b32 s59, 0
L_g_83:
    ds_read_b128 v[8:11], v22 offset:1536
    ds_read_b128 v[12:15], v22 offset:1664
    s_waitcnt lgkmcnt(0)
    v_max_u32 v3, v8, v9
    v_max3_u32 v3, v3, v10, v11
    v_max3_u32 v3, v3, v12, v13
    v_max3_u32 v3, v3, v14, v15
    v_cmp_eq_u32 vcc, -1, v3
    s_cbranch_vccz L_gx_84
    s_sleep 1
    s_add_u32 s59, s59, 1
    s_cmp_lt_u32 s59, 0x800000
    s_cbranch_scc1 L_g_83
L_gx_84:
    v_mfma_f32_16x16x32_bf16 v[72:75], v[8:11], v[40:43], 0
    v_mfma_f32_16x16x32_bf16 v[76:79], v[8:11], v[44:47], 0
    v_mfma_f32_16x16x32_bf16 v[80:83], v[8:11], v[48:51], 0
    v_mfma_f32_16x16x32_bf16 v[84:87], v[8:11], v[52:55], 0
    v_mfma_f32_16x16x32_bf16 v[88:91], v[8:11], v[56:59], 0
    v_mfma_f32_16x16x32_bf16 v[92:95], v[8:11], v[60:63], 0
    v_mfma_f32_16x16x32_bf16 v[96:99], v[8:11], v[64:67], 0
    v_mfma_f32_16x16x32_bf16 v[100:103], v[8:11], v[68:71], 0
    v_mfma_f32_16x16x32_bf16 v[72:75], v[12:15], v[136:139], v[72:75]
    v_mfma_f32_16x16x32_bf16 v[76:79], v[12:15], v[140:143], v[76:79]
    v_mfma_f32_16x16x32_bf16 v[80:83], v[12:15], v[144:147], v[80:83]
    v_mfma_f32_16x16x32_bf16 v[84:87], v[12:15], v[148:151], v[84:87]
    v_mfma_f32_16x16x32_bf16 v[88:91], v[12:15], v[152:155], v[88:91]
    v_mfma_f32_16x16x32_bf16 v[92:95], v[12:15], v[156:159], v[92:95]
    v_mfma_f32_16x16x32_bf16 v[96:99], v[12:15], v[160:163], v[96:99]
    v_mfma_f32_16x16x32_bf16 v[100:103], v[12:15], v[164:167], v[100:103]
    s_mov_b32 s59, 0
L_g_85:
    ds_read_b32 v6, v23 offset:1024
    s_waitcnt lgkmcnt(0)
    v_cmp_eq_u32 vcc, -1, v6
    s_cbranch_vccz L_gx_86
    s_add_u32 s59, s59, 1
    s_cmp_lt_u32 s59, 0x800000
    s_cbranch_scc1 L_g_85
L_gx_86:
    s_nop 1
    v_mul_f32 v72, v6, v72
    v_mul_f32 v88, v6, v88
    v_mul_f32 v76, v6, v76
    v_mul_f32 v92, v6, v92
    v_mul_f32 v80, v6, v80
    v_mul_f32 v96, v6, v96
    v_mul_f32 v84, v6, v84
    v_mul_f32 v100, v6, v100
    v_permlane16_swap_b32 v72, v88
    v_permlane16_swap_b32 v76, v92
    v_permlane16_swap_b32 v80, v96
    v_permlane16_swap_b32 v84, v100
    v_add_f32 v72, v72, v88
    v_add_f32 v76, v76, v92
    v_add_f32 v80, v80, v96
    v_add_f32 v84, v84, v100
    s_nop 0
    v_permlane32_swap_b32 v72, v80
    v_permlane32_swap_b32 v76, v84
    v_add_f32 v8, v72, v80
    v_add_f32 v9, v76, v84
    v_bfi_b32 v8, v24, s8, v8
    v_bfi_b32 v9, v25, s9, v9
    s_bitcmp0_b32 s10, 1
    s_cbranch_scc1 L_ps_87
    buffer_store_dwordx2 v[8:9], v20, s[12:15], s44 offen
L_pb_88:
    s_branch L_wdone
L_fred:
    s_waitcnt vmcnt(1)
    v_perm_b32 v104, v44, v40, s32
    v_perm_b32 v105, v52, v48, s32
    v_perm_b32 v106, v60, v56, s32
    v_perm_b32 v108, v44, v40, s33
    v_perm_b32 v109, v52, v48, s33
    v_perm_b32 v110, v60, v56, s33
    v_perm_b32 v112, v45, v41, s32
    v_perm_b32 v113, v53, v49, s32
    v_perm_b32 v114, v61, v57, s32
    v_perm_b32 v116, v45, v41, s33
    v_perm_b32 v117, v53, v49, s33
    v_perm_b32 v118, v61, v57, s33
    v_perm_b32 v120, v46, v42, s32
    v_perm_b32 v121, v54, v50, s32
    v_perm_b32 v122, v62, v58, s32
    v_perm_b32 v124, v46, v42, s33
    v_perm_b32 v125, v54, v50, s33
    v_perm_b32 v126, v62, v58, s33
    v_perm_b32 v128, v47, v43, s32
    v_perm_b32 v129, v55, v51, s32
    v_perm_b32 v130, v63, v59, s32
    v_perm_b32 v132, v47, v43, s33
    v_perm_b32 v133, v55, v51, s33
    v_perm_b32 v134, v63, v59, s33
    s_waitcnt vmcnt(0)
    v_perm_b32 v107, v68, v64, s32
    v_perm_b32 v111, v68, v64, s33
    v_perm_b32 v115, v69, v65, s32
    v_perm_b32 v119, v69, v65, s33
    v_mfma_f32_16x16x32_bf16 v[136:139], v[36:39], v[104:107], v[136:139]
    v_perm_b32 v123, v70, v66, s32
    v_mfma_f32_16x16x32_bf16 v[140:143], v[36:39], v[108:111], v[140:143]
    v_perm_b32 v127, v70, v66, s33
    v_mfma_f32_16x16x32_bf16 v[144:147], v[36:39], v[112:115], v[144:147]
    v_perm_b32 v131, v71, v67, s32
    v_mfma_f32_16x16x32_bf16 v[148:151], v[36:39], v[116:119], v[148:151]
    v_perm_b32 v135, v71, v67, s33
    v_mfma_f32_16x16x32_bf16 v[152:155], v[36:39], v[120:123], v[152:155]
    v_mfma_f32_16x16x32_bf16 v[156:159], v[36:39], v[124:127], v[156:159]
    v_mfma_f32_16x16x32_bf16 v[160:163], v[36:39], v[128:131], v[160:163]
    v_mfma_f32_16x16x32_bf16 v[164:167], v[36:39], v[132:135], v[164:167]
    s_mov_b32 exec_hi, 0
    ds_write_b128 v18, v[136:139] offset:12288
    ds_write_b128 v18, v[140:143] offset:12320
    ds_write_b128 v18, v[144:147] offset:12352
    ds_write_b128 v18, v[148:151] offset:12384
    ds_write_b128 v18, v[152:155] offset:12416
    ds_write_b128 v18, v[156:159] offset:12448
    ds_write_b128 v18, v[160:163] offset:12480
    ds_write_b128 v18, v[164:167] offset:12512
    v_mov_b32 v3, 1
    s_mov_b64 exec, 1
    ds_add_u32 v5, v3 offset:24
    s_mov_b64 exec, -1
    s_waitcnt lgkmcnt(0)
    s_branch L_opoll
L_wdone:
    s_endpgm
L_comm2:
    v_and_b32 v11, 7, v0
    v_lshlrev_b32 v11, 3, v11
    v_lshrrev_b32 v3, 3, v0
    v_add_u32 v11, v11, v3
    v_lshlrev_b32 v11, 2, v11
    s_lshl_b32 s37, s3, 8
    v_add_u32 v11, s37, v11
    v_lshlrev_b32 v152, 2, v0
    s_add_u32 s34, s34, 1
    s_and_b32 s57, s34, 0xff
    s_mul_i32 s57, s57, 0x01010101
    s_lshl_b32 s35, s2, 9
    s_lshl_b32 s37, s3, 4
    s_add_u32 s35, s35, s37
    s_add_u32 s35, s35, 0x60000
    s_add_u32 s8, s34, 0
    s_and_b32 s8, s8, 15
    s_add_u32 s9, s34, 5
    s_and_b32 s9, s9, 15
    s_lshl_b32 s56, s9, 4
    s_or_b32 s56, s56, s8
    s_mul_i32 s56, s56, 0x01010101
    s_getreg_b32 s11, hwreg(HW_REG_XCC_ID, 0, 4)
    s_lshl_b32 s37, s34, 4
    s_or_b32 s11, s11, s37
    s_lshl_b32 s11, s11, 6
    s_waitcnt vmcnt(7)
    v_lshlrev_b32 v16, 16, v8
    v_and_b32 v17, 0xffff0000, v8
    v_lshlrev_b32 v18, 16, v9
    v_and_b32 v19, 0xffff0000, v9
    v_mul_f32 v20, 0xbfb8aa3b, v16
    v_mul_f32 v21, 0xbfb8aa3b, v17
    v_mul_f32 v22, 0xbfb8aa3b, v18
    v_mul_f32 v23, 0xbfb8aa3b, v19
    v_exp_f32 v20, v20
    v_exp_f32 v21, v21
    v_exp_f32 v22, v22
    v_exp_f32 v23, v23
    v_max_f32 v16, 0xc3000000, v16
    v_max_f32 v17, 0xc3000000, v17
    v_max_f32 v18, 0xc3000000, v18
    v_max_f32 v19, 0xc3000000, v19
    v_add_f32 v20, 1.0, v20
    v_add_f32 v21, 1.0, v21
    v_add_f32 v22, 1.0, v22
    v_add_f32 v23, 1.0, v23
    v_min_f32 v20, 0x7e800000, v20
    v_min_f32 v21, 0x7e800000, v21
    v_min_f32 v22, 0x7e800000, v22
    v_min_f32 v23, 0x7e800000, v23
    v_rcp_f32 v24, v20
    v_rcp_f32 v25, v21
    v_rcp_f32 v26, v22
    v_rcp_f32 v27, v23
    v_mul_f32 v28, v16, v24
    v_mul_f32 v29, v17, v25
    v_mul_f32 v30, v18, v26
    v_mul_f32 v31, v19, v27
    v_fma_f32 v20, -v28, v20, v16
    v_fma_f32 v21, -v29, v21, v17
    v_fma_f32 v22, -v30, v22, v18
    v_fma_f32 v23, -v31, v23, v19
    v_fma_f32 v16, v20, v24, v28
    v_fma_f32 v17, v21, v25, v29
    v_fma_f32 v18, v22, v26, v30
    v_fma_f32 v19, v23, v27, v31
    v_cvt_pk_bf16_f32 v8, v16, v17
    v_cvt_pk_bf16_f32 v9, v18, v19
    s_waitcnt vmcnt(3)
    s_add_u32 s37, s36, 16384
    buffer_load_dwordx4 v[64:67], v6, s[20:23], s37 offen nt
    s_add_u32 s37, s36, 24576
    buffer_load_dwordx4 v[68:71], v6, s[20:23], s37 offen nt
    s_add_u32 s37, s36, 262144
    buffer_load_dwordx4 v[72:75], v6, s[20:23], s37 offen nt
    s_add_u32 s37, s36, 270336
    buffer_load_dwordx4 v[76:79], v6, s[20:23], s37 offen nt
    v_perm_b32 v88, v44, v40, s32
    v_perm_b32 v89, v44, v40, s33
    v_perm_b32 v90, v45, v41, s32
    v_perm_b32 v91, v45, v41, s33
    v_perm_b32 v92, v46, v42, s32
    v_perm_b32 v93, v46, v42, s33
    v_perm_b32 v94, v47, v43, s32
    v_perm_b32 v95, v47, v43, s33
    v_perm_b32 v96, v52, v48, s32
    v_perm_b32 v97, v52, v48, s33
    v_perm_b32 v98, v53, v49, s32
    v_perm_b32 v99, v53, v49, s33
    v_perm_b32 v100, v54, v50, s32
    v_perm_b32 v101, v54, v50, s33
    v_perm_b32 v102, v55, v51, s32
    v_perm_b32 v103, v55, v51, s33
    v_dot2_f32_bf16 v16, v88, v8, 0
    v_dot2_f32_bf16 v17, v89, v8, 0
    v_dot2_f32_bf16 v18, v90, v8, 0
    v_dot2_f32_bf16 v19, v91, v8, 0
    v_dot2_f32_bf16 v20, v92, v8, 0
    v_dot2_f32_bf16 v21, v93, v8, 0
    v_dot2_f32_bf16 v22, v94, v8, 0
    v_dot2_f32_bf16 v23, v95, v8, 0
    v_dot2_f32_bf16 v16, v96, v9, v16
    v_dot2_f32_bf16 v17, v97, v9, v17
    v_dot2_f32_bf16 v18, v98, v9, v18
    v_dot2_f32_bf16 v19, v99, v9, v19
    v_dot2_f32_bf16 v20, v100, v9, v20
    v_dot2_f32_bf16 v21, v101, v9, v21
    v_dot2_f32_bf16 v22, v102, v9, v22
    v_dot2_f32_bf16 v23, v103, v9, v23
    v_permlane32_swap_b32 v16, v20
    v_permlane32_swap_b32 v17, v21
    v_permlane32_swap_b32 v18, v22
    v_permlane32_swap_b32 v19, v23
    v_add_f32 v16, v16, v20
    v_add_f32 v17, v17, v21
    v_add_f32 v18, v18, v22
    v_add_f32 v19, v19, v23
    s_nop 0
    v_permlane16_swap_b32 v16, v18
    v_permlane16_swap_b32 v17, v19
    v_add_f32 v16, v16, v18
    v_add_f32 v17, v17, v19
    s_nop 0
    v_add_f32_dpp v3, v16, v16 row_ror:8 row_mask:0xf bank_mask:0x3
    s_nop 1
    v_add_f32_dpp v3, v17, v17 row_ror:8 row_mask:0xf bank_mask:0xc
    ds_write_b32 v11, v3 offset:3072
    s_waitcnt vmcnt(6)
    v_mov_b32 v3, 1
    s_mov_b64 exec, 1
    ds_add_rtn_u32 v3, v7, v3 offset:12
    s_mov_b64 exec, -1
    s_waitcnt lgkmcnt(0)
    v_readfirstlane_b32 s37, v3
    s_nop 0
    s_cmp_lg_u32 s37, 3
    s_cbranch_scc1 L_la_89
    ds_read_b32 v12, v152 offset:3072
    ds_read_b32 v13, v152 offset:3328
    ds_read_b32 v14, v152 offset:3584
    ds_read_b32 v15, v152 offset:3840
    s_waitcnt lgkmcnt(0)
    v_add_f32 v12, v12, v13
    v_add_f32 v14, v14, v15
    v_add_f32 v12, v12, v14
    v_mov_b32 v13, s34
    v_lshlrev_b32 v3, 3, v0
    s_and_b32 s37, s2, 31
    s_lshl_b32 s37, s37, 3
    s_lshr_b32 s38, s2, 5
    s_add_u32 s37, s37, s38
    s_lshl_b32 s37, s37, 9
    s_add_u32 s37, s37, 0x10000
    buffer_store_dwordx2 v[12:13], v3, s[12:15], s37 offen sc1
L_la_89:
    s_waitcnt vmcnt(5)
    s_add_u32 s37, s36, 278528
    buffer_load_dwordx4 v[80:83], v6, s[20:23], s37 offen nt
    s_waitcnt vmcnt(5)
    s_add_u32 s37, s36, 286720
    buffer_load_dwordx4 v[84:87], v6, s[20:23], s37 offen nt
    s_lshl_b32 s50, s48, 2
    s_add_u32 s50, s50, 0x8000
    s_cmp_lg_u32 s49, s44
    s_cbranch_scc1 L_nomaker
    s_barrier
    v_and_b32 v5, 31, v0
    v_lshlrev_b32 v5, 1, v5
    v_lshrrev_b32 v3, 5, v0
    v_add_u32 v5, v5, v3
    v_lshlrev_b32 v5, 1, v5
    s_lshl_b32 s37, s48, 1
    buffer_load_dwordx4 v[156:159], v4, s[28:31], 0 offen
    buffer_load_dwordx4 v[160:163], v4, s[28:31], 0 offen offset:1024
    buffer_load_ushort v10, v5, s[28:31], s37 offen
    s_lshl_b32 s38, s48, 6
    s_add_u32 s38, s38, 0x10000
    s_add_u32 s39, s38, 0x10000
    s_mov_b32 s59, 0
L_sw_90:
    s_load_dword s60, s[12:13], s38 offset:0x4 glc
    s_load_dword s61, s[12:13], s38 offset:0x204 glc
    s_load_dword s62, s[12:13], s38 offset:0x404 glc
    s_load_dword s63, s[12:13], s38 offset:0x604 glc
    s_load_dword s64, s[12:13], s38 offset:0x804 glc
    s_load_dword s65, s[12:13], s38 offset:0xa04 glc
    s_load_dword s66, s[12:13], s38 offset:0xc04 glc
    s_load_dword s67, s[12:13], s38 offset:0xe04 glc
    s_load_dword s68, s[12:13], s38 offset:0x10004 glc
    s_load_dword s69, s[12:13], s38 offset:0x10204 glc
    s_load_dword s70, s[12:13], s38 offset:0x10404 glc
    s_load_dword s71, s[12:13], s38 offset:0x10604 glc
    s_load_dword s72, s[12:13], s38 offset:0x10804 glc
    s_load_dword s73, s[12:13], s38 offset:0x10a04 glc
    s_load_dword s74, s[12:13], s38 offset:0x10c04 glc
    s_load_dword s75, s[12:13], s38 offset:0x10e04 glc
    s_waitcnt lgkmcnt(0)
    s_xor_b32 s60, s60, s34
    s_xor_b32 s61, s61, s34
    s_xor_b32 s62, s62, s34
    s_xor_b32 s63, s63, s34
    s_xor_b32 s64, s64, s34
    s_xor_b32 s65, s65, s34
    s_xor_b32 s66, s66, s34
    s_xor_b32 s67, s67, s34
    s_xor_b32 s68, s68, s34
    s_xor_b32 s69, s69, s34
    s_xor_b32 s70, s70, s34
    s_xor_b32 s71, s71, s34
    s_xor_b32 s72, s72, s34
    s_xor_b32 s73, s73, s34
    s_xor_b32 s74, s74, s34
    s_xor_b32 s75, s75, s34
    s_or_b32 s60, s60, s61
    s_or_b32 s60, s60, s62
    s_or_b32 s60, s60, s63
    s_or_b32 s60, s60, s64
    s_or_b32 s60, s60, s65
    s_or_b32 s60, s60, s66
    s_or_b32 s60, s60, s67
    s_or_b32 s60, s60, s68
    s_or_b32 s60, s60, s69
    s_or_b32 s60, s60, s70
    s_or_b32 s60, s60, s71
    s_or_b32 s60, s60, s72
    s_or_b32 s60, s60, s73
    s_or_b32 s60, s60, s74
    s_or_b32 s60, s60, s75
    s_cmp_eq_u32 s60, 0
    s_cbranch_scc1 L_swx_91
    s_add_u32 s59, s59, 1
    s_cmp_lt_u32 s59, 0x1000
    s_cbranch_scc1 L_sw_90
L_swx_91:
    s_mov_b32 s59, 0
L_g_92:
    buffer_load_dwordx4 v[120:123], v4, s[12:15], s38 offen offset:0 sc1
    buffer_load_dwordx4 v[124:127], v4, s[12:15], s38 offen offset:1024 sc1
    buffer_load_dwordx4 v[128:131], v4, s[12:15], s38 offen offset:2048 sc1
    buffer_load_dwordx4 v[132:135], v4, s[12:15], s38 offen offset:3072 sc1
    buffer_load_dwordx4 v[136:139], v4, s[12:15], s39 offen offset:0 sc1
    buffer_load_dwordx4 v[140:143], v4, s[12:15], s39 offen offset:1024 sc1
    buffer_load_dwordx4 v[144:147], v4, s[12:15], s39 offen offset:2048 sc1
    buffer_load_dwordx4 v[148:151], v4, s[12:15], s39 offen offset:3072 sc1
    s_waitcnt vmcnt(0)
    v_max_u32 v16, v121, v123
    v_min_u32 v17, v121, v123
    v_max3_u32 v16, v16, v125, v127
    v_min3_u32 v17, v17, v125, v127
    v_max3_u32 v16, v16, v129, v131
    v_min3_u32 v17, v17, v129, v131
    v_max3_u32 v16, v16, v133, v135
    v_min3_u32 v17, v17, v133, v135
    v_max3_u32 v16, v16, v137, v139
    v_min3_u32 v17, v17, v137, v139
    v_max3_u32 v16, v16, v141, v143
    v_min3_u32 v17, v17, v141, v143
    v_max3_u32 v16, v16, v145, v147
    v_min3_u32 v17, v17, v145, v147
    v_max3_u32 v16, v16, v149, v151
    v_min3_u32 v17, v17, v149, v151
    v_xor_b32 v16, s34, v16
    v_xor_b32 v17, s34, v17
    v_or_b32 v16, v16, v17
    v_cmp_ne_u32 vcc, 0, v16
    s_cbranch_vccz L_gx_93
    s_add_u32 s59, s59, 1
    s_cmp_lt_u32 s59, 0x100000
    s_cbranch_scc1 L_g_92
L_gx_93:
    v_lshlrev_b32 v20, 16, v156
    v_and_b32 v21, 0xffff0000, v156
    v_lshlrev_b32 v22, 16, v157
    v_and_b32 v23, 0xffff0000, v157
    v_lshlrev_b32 v24, 16, v158
    v_and_b32 v25, 0xffff0000, v158
    v_lshlrev_b32 v26, 16, v159
    v_and_b32 v27, 0xffff0000, v159
    v_lshlrev_b32 v28, 16, v160
    v_and_b32 v29, 0xffff0000, v160
    v_lshlrev_b32 v30, 16, v161
    v_and_b32 v31, 0xffff0000, v161
    v_lshlrev_b32 v32, 16, v162
    v_and_b32 v33, 0xffff0000, v162
    v_lshlrev_b32 v34, 16, v163
    v_and_b32 v35, 0xffff0000, v163
    v_readfirstlane_b32 s40, v20
    v_lshlrev_b32 v10, 16, v10
    s_mov_b32 s41, s40
    v_pk_add_f32 v[20:21], v[20:21], s[40:41] neg_lo:[0,1] neg_hi:[0,1]
    v_pk_add_f32 v[22:23], v[22:23], s[40:41] neg_lo:[0,1] neg_hi:[0,1]
    v_pk_add_f32 v[24:25], v[24:25], s[40:41] neg_lo:[0,1] neg_hi:[0,1]
    v_pk_add_f32 v[26:27], v[26:27], s[40:41] neg_lo:[0,1] neg_hi:[0,1]
    v_pk_add_f32 v[28:29], v[28:29], s[40:41] neg_lo:[0,1] neg_hi:[0,1]
    v_pk_add_f32 v[30:31], v[30:31], s[40:41] neg_lo:[0,1] neg_hi:[0,1]
    v_pk_add_f32 v[32:33], v[32:33], s[40:41] neg_lo:[0,1] neg_hi:[0,1]
    v_pk_add_f32 v[34:35], v[34:35], s[40:41] neg_lo:[0,1] neg_hi:[0,1]
    v_pk_mul_f32 v[18:19], v[20:21], v[20:21]
    v_pk_add_f32 v[16:17], v[20:21], v[22:23]
    v_pk_fma_f32 v[18:19], v[22:23], v[22:23], v[18:19]
    v_pk_fma_f32 v[18:19], v[24:25], v[24:25], v[18:19]
    v_pk_add_f32 v[16:17], v[16:17], v[24:25]
    v_pk_fma_f32 v[18:19], v[26:27], v[26:27], v[18:19]
    v_pk_add_f32 v[16:17], v[16:17], v[26:27]
    v_pk_fma_f32 v[18:19], v[28:29], v[28:29], v[18:19]
    v_pk_add_f32 v[16:17], v[16:17], v[28:29]
    v_pk_fma_f32 v[18:19], v[30:31], v[30:31], v[18:19]
    v_pk_add_f32 v[16:17], v[16:17], v[30:31]
    v_pk_fma_f32 v[18:19], v[32:33], v[32:33], v[18:19]
    v_pk_add_f32 v[16:17], v[16:17], v[32:33]
    v_pk_fma_f32 v[18:19], v[34:35], v[34:35], v[18:19]
    v_pk_add_f32 v[16:17], v[16:17], v[34:35]
    v_add_f32 v16, v16, v17
    v_add_f32 v17, v18, v19
    s_nop 1
    v_permlane32_swap_b32 v16, v17
    v_add_f32 v16, v16, v17
    v_mov_b32 v17, v16
    s_nop 1
    v_permlane16_swap_b32 v16, v17
    v_add_f32 v16, v16, v17
    s_nop 1
    v_add_f32_dpp v16, v16, v16 row_ror:8 row_mask:0xf bank_mask:0xf
    s_nop 1
    v_add_f32_dpp v16, v16, v16 row_ror:4 row_mask:0xf bank_mask:0xf
    s_nop 1
    v_add_f32_dpp v16, v16, v16 row_ror:2 row_mask:0xf bank_mask:0xf
    s_nop 1
    v_add_f32_dpp v16, v16, v16 row_ror:1 row_mask:0xf bank_mask:0xf
    v_mul_f32 v16, 0x3a800000, v16
    s_nop 0
    v_readlane_b32 s42, v16, 0
    v_readlane_b32 s43, v16, 32
    s_nop 0
    v_mov_b32 v17, s42
    v_add_f32 v16, s40, v17
    v_fma_f32 v17, -v17, v17, s43
    v_max_f32 v17, 0, v17
    v_cvt_pk_bf16_f32 v16, v16, v17
    v_and_b32 v17, 0xffff0000, v16
    v_lshlrev_b32 v16, 16, v16
    v_add_f32 v17, 0x3727c5ac, v17
    v_sub_f32 v10, v10, v16
    v_cvt_pk_bf16_f32 v16, v10, v17
    v_and_b32 v17, 0xffff0000, v16
    v_sqrt_f32 v17, v17
    v_lshlrev_b32 v10, 16, v16
    v_cvt_pk_bf16_f32 v17, v17, v17
    v_lshlrev_b32 v17, 16, v17
    v_rcp_f32 v18, v17
    s_nop 0
    v_mul_f32 v16, v10, v18
    v_fma_f32 v19, -v16, v17, v10
    v_fma_f32 v10, v19, v18, v16
    v_cvt_pk_bf16_f32 v10, v10, v10
    v_lshlrev_b32 v10, 16, v10
    v_add_f32 v120, v120, v124
    v_add_f32 v128, v128, v132
    v_add_f32 v120, v120, v128
    v_add_f32 v122, v122, v126
    v_add_f32 v130, v130, v134
    v_add_f32 v122, v122, v130
    v_add_f32 v136, v136, v140
    v_add_f32 v144, v144, v148
    v_add_f32 v136, v136, v144
    v_add_f32 v138, v138, v142
    v_add_f32 v146, v146, v150
    v_add_f32 v138, v138, v146
    v_permlane32_swap_b32 v120, v122
    s_nop 0
    v_permlane32_swap_b32 v136, v138
    v_add_f32 v16, v120, v122
    v_add_f32 v17, v136, v138
    v_cvt_pk_bf16_f32 v16, v16, v17
    v_and_b32 v17, 0xffff0000, v16
    v_lshlrev_b32 v16, 16, v16
    v_add_f32 v17, 1.0, v17
    v_cvt_pk_bf16_f32 v17, v17, v17
    v_lshlrev_b32 v17, 16, v17
    v_mul_f32 v17, v10, v17
    v_cvt_pk_bf16_f32 v17, v17, v17
    v_lshlrev_b32 v17, 16, v17
    v_add_f32 v17, v17, v16
    v_mov_b32 v16, v17
    s_nop 1
    v_permlane32_swap_b32 v16, v17
    v_cvt_pk_bf16_f32 v16, v16, v17
    v_mov_b32 v17, s34
    v_lshlrev_b32 v3, 3, v0
    s_mov_b32 exec_hi, 0
    buffer_store_dwordx2 v[16:17], v3, s[12:15], s50 offen sc1
    s_mov_b64 exec, -1
    v_mov_b32 v54, s57
    v_lshlrev_b32 v55, 9, v0
    s_lshl_b32 s37, s47, 15
    s_lshl_b32 s38, s3, 4
    s_add_u32 s37, s37, s38
    s_add_u32 s37, s37, 0x60000
    buffer_store_dword v54, v55, s[12:15], s37 offen offset:0 sc1
    v_perm_b32 v88, v60, v56, s32
    v_perm_b32 v89, v60, v56, s33
    v_perm_b32 v90, v61, v57, s32
    v_perm_b32 v91, v61, v57, s33
    v_perm_b32 v92, v62, v58, s32
    v_perm_b32 v93, v62, v58, s33
    v_perm_b32 v94, v63, v59, s32
    v_perm_b32 v95, v63, v59, s33
    v_perm_b32 v96, v68, v64, s32
    v_perm_b32 v97, v68, v64, s33
    v_perm_b32 v98, v69, v65, s32
    v_perm_b32 v99, v69, v65, s33
    v_perm_b32 v100, v70, v66, s32
    v_perm_b32 v101, v70, v66, s33
    v_perm_b32 v102, v71, v67, s32
    v_perm_b32 v103, v71, v67, s33
    v_perm_b32 v104, v76, v72, s32
    v_perm_b32 v105, v76, v72, s33
    v_perm_b32 v106, v77, v73, s32
    v_perm_b32 v107, v77, v73, s33
    v_perm_b32 v108, v78, v74, s32
    v_perm_b32 v109, v78, v74, s33
    v_perm_b32 v110, v79, v75, s32
    v_perm_b32 v111, v79, v75, s33
    v_perm_b32 v112, v84, v80, s32
    v_perm_b32 v113, v84, v80, s33
    v_perm_b32 v114, v85, v81, s32
    v_perm_b32 v115, v85, v81, s33
    v_perm_b32 v116, v86, v82, s32
    v_perm_b32 v117, v86, v82, s33
    v_perm_b32 v118, v87, v83, s32
    v_perm_b32 v119, v87, v83, s33
    s_branch L_mrj
L_nomaker:
    s_lshl_b32 s37, s48, 1
    buffer_load_dwordx2 v[36:37], v2, s[24:27], s37 offen
    buffer_load_dwordx2 v[38:39], v2, s[24:27], s37 offen offset:64
    s_mul_i32 s36, s48, 12288
    s_add_u32 s36, s36, s45
    s_add_u32 s36, s36, 4096
    s_add_u32 s37, s36, 0
    s_waitcnt vmcnt(7)
    buffer_load_dwordx4 v[120:123], v1, s[16:19], s37 offen nt
    s_add_u32 s37, s36, 12288
    s_waitcnt vmcnt(7)
    buffer_load_dwordx4 v[124:127], v1, s[16:19], s37 offen nt
    s_add_u32 s37, s36, 24576
    s_waitcnt vmcnt(7)
    buffer_load_dwordx4 v[128:131], v1, s[16:19], s37 offen nt
    s_add_u32 s37, s36, 36864
    s_waitcnt vmcnt(7)
    buffer_load_dwordx4 v[132:135], v1, s[16:19], s37 offen nt
    s_add_u32 s37, s36, 393216
    s_waitcnt vmcnt(7)
    buffer_load_dwordx4 v[136:139], v1, s[16:19], s37 offen nt
    s_add_u32 s37, s36, 405504
    s_waitcnt vmcnt(7)
    buffer_load_dwordx4 v[140:143], v1, s[16:19], s37 offen nt
    s_add_u32 s37, s36, 417792
    s_waitcnt vmcnt(5)
    buffer_load_dwordx4 v[144:147], v1, s[16:19], s37 offen nt
    s_add_u32 s37, s36, 430080
    s_waitcnt vmcnt(5)
    buffer_load_dwordx4 v[148:151], v1, s[16:19], s37 offen nt
    s_barrier
    s_waitcnt vmcnt(10)
    v_perm_b32 v88, v60, v56, s32
    v_perm_b32 v89, v60, v56, s33
    v_perm_b32 v90, v61, v57, s32
    v_perm_b32 v91, v61, v57, s33
    v_perm_b32 v92, v62, v58, s32
    v_perm_b32 v93, v62, v58, s33
    v_perm_b32 v94, v63, v59, s32
    v_perm_b32 v95, v63, v59, s33
    v_perm_b32 v96, v68, v64, s32
    v_perm_b32 v97, v68, v64, s33
    v_perm_b32 v98, v69, v65, s32
    v_perm_b32 v99, v69, v65, s33
    v_perm_b32 v100, v70, v66, s32
    v_perm_b32 v101, v70, v66, s33
    v_perm_b32 v102, v71, v67, s32
    v_perm_b32 v103, v71, v67, s33
    v_perm_b32 v104, v76, v72, s32
    v_perm_b32 v105, v76, v72, s33
    v_perm_b32 v106, v77, v73, s32
    v_perm_b32 v107, v77, v73, s33
    v_perm_b32 v108, v78, v74, s32
    v_perm_b32 v109, v78, v74, s33
    v_perm_b32 v110, v79, v75, s32
    v_perm_b32 v111, v79, v75, s33
    v_perm_b32 v112, v84, v80, s32
    v_perm_b32 v113, v84, v80, s33
    v_perm_b32 v114, v85, v81, s32
    v_perm_b32 v115, v85, v81, s33
    v_perm_b32 v116, v86, v82, s32
    v_perm_b32 v117, v86, v82, s33
    v_perm_b32 v118, v87, v83, s32
    v_perm_b32 v119, v87, v83, s33
    s_waitcnt vmcnt(8)
    v_lshlrev_b32 v16, 16, v36
    v_and_b32 v17, 0xffff0000, v36
    v_lshlrev_b32 v18, 16, v37
    v_and_b32 v19, 0xffff0000, v37
    v_mul_f32 v20, 0xbfb8aa3b, v16
    v_mul_f32 v21, 0xbfb8aa3b, v17
    v_mul_f32 v22, 0xbfb8aa3b, v18
    v_mul_f32 v23, 0xbfb8aa3b, v19
    v_exp_f32 v20, v20
    v_exp_f32 v21, v21
    v_exp_f32 v22, v22
    v_exp_f32 v23, v23
    v_max_f32 v16, 0xc3000000, v16
    v_max_f32 v17, 0xc3000000, v17
    v_max_f32 v18, 0xc3000000, v18
    v_max_f32 v19, 0xc3000000, v19
    v_add_f32 v20, 1.0, v20
    v_add_f32 v21, 1.0, v21
    v_add_f32 v22, 1.0, v22
    v_add_f32 v23, 1.0, v23
    v_min_f32 v20, 0x7e800000, v20
    v_min_f32 v21, 0x7e800000, v21
    v_min_f32 v22, 0x7e800000, v22
    v_min_f32 v23, 0x7e800000, v23
    v_rcp_f32 v24, v20
    v_rcp_f32 v25, v21
    v_rcp_f32 v26, v22
    v_rcp_f32 v27, v23
    v_mul_f32 v28, v16, v24
    v_mul_f32 v29, v17, v25
    v_mul_f32 v30, v18, v26
    v_mul_f32 v31, v19, v27
    v_fma_f32 v20, -v28, v20, v16
    v_fma_f32 v21, -v29, v21, v17
    v_fma_f32 v22, -v30, v22, v18
    v_fma_f32 v23, -v31, v23, v19
    v_fma_f32 v16, v20, v24, v28
    v_fma_f32 v17, v21, v25, v29
    v_fma_f32 v18, v22, v26, v30
    v_fma_f32 v19, v23, v27, v31
    v_cvt_pk_bf16_f32 v36, v16, v17
    v_cvt_pk_bf16_f32 v37, v18, v19
    v_lshlrev_b32 v16, 16, v38
    v_and_b32 v17, 0xffff0000, v38
    v_lshlrev_b32 v18, 16, v39
    v_and_b32 v19, 0xffff0000, v39
    v_mul_f32 v20, 0xbfb8aa3b, v16
    v_mul_f32 v21, 0xbfb8aa3b, v17
    v_mul_f32 v22, 0xbfb8aa3b, v18
    v_mul_f32 v23, 0xbfb8aa3b, v19
    v_exp_f32 v20, v20
    v_exp_f32 v21, v21
    v_exp_f32 v22, v22
    v_exp_f32 v23, v23
    v_max_f32 v16, 0xc3000000, v16
    v_max_f32 v17, 0xc3000000, v17
    v_max_f32 v18, 0xc3000000, v18
    v_max_f32 v19, 0xc3000000, v19
    v_add_f32 v20, 1.0, v20
    v_add_f32 v21, 1.0, v21
    v_add_f32 v22, 1.0, v22
    v_add_f32 v23, 1.0, v23
    v_min_f32 v20, 0x7e800000, v20
    v_min_f32 v21, 0x7e800000, v21
    v_min_f32 v22, 0x7e800000, v22
    v_min_f32 v23, 0x7e800000, v23
    v_rcp_f32 v24, v20
    v_rcp_f32 v25, v21
    v_rcp_f32 v26, v22
    v_rcp_f32 v27, v23
    v_mul_f32 v28, v16, v24
    v_mul_f32 v29, v17, v25
    v_mul_f32 v30, v18, v26
    v_mul_f32 v31, v19, v27
    v_fma_f32 v20, -v28, v20, v16
    v_fma_f32 v21, -v29, v21, v17
    v_fma_f32 v22, -v30, v22, v18
    v_fma_f32 v23, -v31, v23, v19
    v_fma_f32 v16, v20, v24, v28
    v_fma_f32 v17, v21, v25, v29
    v_fma_f32 v18, v22, v26, v30
    v_fma_f32 v19, v23, v27, v31
    v_cvt_pk_bf16_f32 v38, v16, v17
    v_cvt_pk_bf16_f32 v39, v18, v19
    s_waitcnt vmcnt(4)
    v_perm_b32 v40, v124, v120, s32
    v_perm_b32 v41, v124, v120, s33
    v_perm_b32 v42, v125, v121, s32
    v_perm_b32 v43, v125, v121, s33
    v_perm_b32 v44, v126, v122, s32
    v_perm_b32 v45, v126, v122, s33
    v_perm_b32 v46, v127, v123, s32
    v_perm_b32 v47, v127, v123, s33
    v_perm_b32 v48, v132, v128, s32
    v_perm_b32 v49, v132, v128, s33
    v_perm_b32 v50, v133, v129, s32
    v_perm_b32 v51, v133, v129, s33
    v_perm_b32 v52, v134, v130, s32
    v_perm_b32 v53, v134, v130, s33
    v_perm_b32 v54, v135, v131, s32
    v_perm_b32 v55, v135, v131, s33
    v_dot2_f32_bf16 v16, v40, v36, 0
    v_dot2_f32_bf16 v17, v41, v36, 0
    v_dot2_f32_bf16 v18, v42, v36, 0
    v_dot2_f32_bf16 v19, v43, v36, 0
    v_dot2_f32_bf16 v20, v44, v36, 0
    v_dot2_f32_bf16 v21, v45, v36, 0
    v_dot2_f32_bf16 v22, v46, v36, 0
    v_dot2_f32_bf16 v23, v47, v36, 0
    v_dot2_f32_bf16 v16, v48, v37, v16
    v_dot2_f32_bf16 v17, v49, v37, v17
    v_dot2_f32_bf16 v18, v50, v37, v18
    v_dot2_f32_bf16 v19, v51, v37, v19
    v_dot2_f32_bf16 v20, v52, v37, v20
    v_dot2_f32_bf16 v21, v53, v37, v21
    v_dot2_f32_bf16 v22, v54, v37, v22
    v_dot2_f32_bf16 v23, v55, v37, v23
    s_waitcnt vmcnt(0)
    v_perm_b32 v40, v140, v136, s32
    v_perm_b32 v41, v140, v136, s33
    v_perm_b32 v42, v141, v137, s32
    v_perm_b32 v43, v141, v137, s33
    v_perm_b32 v44, v142, v138, s32
    v_perm_b32 v45, v142, v138, s33
    v_perm_b32 v46, v143, v139, s32
    v_perm_b32 v47, v143, v139, s33
    v_perm_b32 v48, v148, v144, s32
    v_perm_b32 v49, v148, v144, s33
    v_perm_b32 v50, v149, v145, s32
    v_perm_b32 v51, v149, v145, s33
    v_perm_b32 v52, v150, v146, s32
    v_perm_b32 v53, v150, v146, s33
    v_perm_b32 v54, v151, v147, s32
    v_perm_b32 v55, v151, v147, s33
    v_dot2_f32_bf16 v16, v40, v38, v16
    v_dot2_f32_bf16 v17, v41, v38, v17
    v_dot2_f32_bf16 v18, v42, v38, v18
    v_dot2_f32_bf16 v19, v43, v38, v19
    v_dot2_f32_bf16 v20, v44, v38, v20
    v_dot2_f32_bf16 v21, v45, v38, v21
    v_dot2_f32_bf16 v22, v46, v38, v22
    v_dot2_f32_bf16 v23, v47, v38, v23
    v_dot2_f32_bf16 v16, v48, v39, v16
    v_dot2_f32_bf16 v17, v49, v39, v17
    v_dot2_f32_bf16 v18, v50, v39, v18
    v_dot2_f32_bf16 v19, v51, v39, v19
    v_dot2_f32_bf16 v20, v52, v39, v20
    v_dot2_f32_bf16 v21, v53, v39, v21
    v_dot2_f32_bf16 v22, v54, v39, v22
    v_dot2_f32_bf16 v23, v55, v39, v23
    v_permlane32_swap_b32 v16, v20
    v_permlane32_swap_b32 v17, v21
    v_permlane32_swap_b32 v18, v22
    v_permlane32_swap_b32 v19, v23
    v_add_f32 v16, v16, v20
    v_add_f32 v17, v17, v21
    v_add_f32 v18, v18, v22
    v_add_f32 v19, v19, v23
    s_nop 0
    v_permlane16_swap_b32 v16, v18
    v_permlane16_swap_b32 v17, v19
    v_add_f32 v16, v16, v18
    v_add_f32 v17, v17, v19
    s_nop 0
    v_add_f32_dpp v3, v16, v16 row_ror:8 row_mask:0xf bank_mask:0x3
    s_nop 1
    v_add_f32_dpp v3, v17, v17 row_ror:8 row_mask:0xf bank_mask:0xc
    ds_write_b32 v11, v3 offset:5120
    v_mov_b32 v3, 1
    s_mov_b64 exec, 1
    ds_add_rtn_u32 v3, v7, v3 offset:20
    s_mov_b64 exec, -1
    s_waitcnt lgkmcnt(0)
    v_readfirstlane_b32 s37, v3
    s_nop 0
    s_cmp_lg_u32 s37, 3
    s_cbranch_scc1 L_la_94
    ds_read_b32 v12, v152 offset:5120
    ds_read_b32 v13, v152 offset:5376
    ds_read_b32 v14, v152 offset:5632
    ds_read_b32 v15, v152 offset:5888
    s_waitcnt lgkmcnt(0)
    v_add_f32 v12, v12, v13
    v_add_f32 v14, v14, v15
    v_add_f32 v12, v12, v14
    v_min_u32 v12, -2, v12
    s_add_u32 s37, s46, 0x40000
    buffer_store_dword v12, v152, s[12:15], s37 offen sc1
L_la_94:
L_mrj:
    s_bfe_u32 s47, s2, 0x20001
    s_lshl_b32 s51, s47, 2
    s_add_u32 s51, s51, s3
    s_lshl_b32 s51, s51, 2
    v_bfe_u32 v3, v0, 2, 2
    v_lshlrev_b32 v3, 6, v3
    v_and_b32 v8, 3, v0
    v_add3_u32 v3, v3, v8, s51
    v_and_b32 v8, 31, v3
    v_lshlrev_b32 v8, 3, v8
    v_lshrrev_b32 v3, 5, v3
    v_add_u32 v3, v3, v8
    v_lshlrev_b32 v5, 9, v3
    v_lshlrev_b32 v6, 1, v2
    s_mov_b32 s38, 0x10000
    s_mov_b32 s59, 0
L_fw_95:
    s_load_dword s60, s[12:13], s35 offset:0x0 glc
    s_waitcnt lgkmcnt(0)
    s_xor_b32 s60, s60, s57
    s_cmp_eq_u32 s60, 0
    s_cbranch_scc1 L_fwx_96
    s_sleep 2
    s_add_u32 s59, s59, 1
    s_cmp_lt_u32 s59, 0x1000
    s_cbranch_scc1 L_fw_95
L_fwx_96:
    s_mov_b32 s59, 0
L_g_97:
    buffer_load_dwordx4 v[24:27], v6, s[12:15], s50 offen sc1
    buffer_load_dwordx4 v[28:31], v6, s[12:15], s50 offen offset:128 sc1
    buffer_load_dword v8, v5, s[12:15], s38 offen offset:4 sc1
    s_waitcnt vmcnt(0)
    v_max_u32 v16, v25, v27
    v_min_u32 v17, v25, v27
    v_max3_u32 v16, v16, v29, v31
    v_min3_u32 v17, v17, v29, v31
    v_max3_u32 v16, v16, v8, v8
    v_min3_u32 v17, v17, v8, v8
    v_xor_b32 v16, s34, v16
    v_xor_b32 v17, s34, v17
    v_or_b32 v16, v16, v17
    v_cmp_ne_u32 vcc, 0, v16
    s_cbranch_vccz L_gx_98
    s_add_u32 s59, s59, 1
    s_cmp_lt_u32 s59, 0x100000
    s_cbranch_scc1 L_g_97
L_gx_98:
    v_dot2_f32_bf16 v16, v88, v24, 0
    v_dot2_f32_bf16 v17, v89, v24, 0
    v_dot2_f32_bf16 v18, v90, v24, 0
    v_dot2_f32_bf16 v19, v91, v24, 0
    v_dot2_f32_bf16 v20, v92, v24, 0
    v_dot2_f32_bf16 v21, v93, v24, 0
    v_dot2_f32_bf16 v22, v94, v24, 0
    v_dot2_f32_bf16 v23, v95, v24, 0
    v_dot2_f32_bf16 v16, v96, v26, v16
    v_dot2_f32_bf16 v17, v97, v26, v17
    v_dot2_f32_bf16 v18, v98, v26, v18
    v_dot2_f32_bf16 v19, v99, v26, v19
    v_dot2_f32_bf16 v20, v100, v26, v20
    v_dot2_f32_bf16 v21, v101, v26, v21
    v_dot2_f32_bf16 v22, v102, v26, v22
    v_dot2_f32_bf16 v23, v103, v26, v23
    v_dot2_f32_bf16 v16, v104, v28, v16
    v_dot2_f32_bf16 v17, v105, v28, v17
    v_dot2_f32_bf16 v18, v106, v28, v18
    v_dot2_f32_bf16 v19, v107, v28, v19
    v_dot2_f32_bf16 v20, v108, v28, v20
    v_dot2_f32_bf16 v21, v109, v28, v21
    v_dot2_f32_bf16 v22, v110, v28, v22
    v_dot2_f32_bf16 v23, v111, v28, v23
    v_dot2_f32_bf16 v16, v112, v30, v16
    v_dot2_f32_bf16 v17, v113, v30, v17
    v_dot2_f32_bf16 v18, v114, v30, v18
    v_dot2_f32_bf16 v19, v115, v30, v19
    v_dot2_f32_bf16 v20, v116, v30, v20
    v_dot2_f32_bf16 v21, v117, v30, v21
    v_dot2_f32_bf16 v22, v118, v30, v22
    v_dot2_f32_bf16 v23, v119, v30, v23
    v_permlane32_swap_b32 v16, v20
    v_permlane32_swap_b32 v17, v21
    v_permlane32_swap_b32 v18, v22
    v_permlane32_swap_b32 v19, v23
    v_add_f32 v16, v16, v20
    v_add_f32 v17, v17, v21
    v_add_f32 v18, v18, v22
    v_add_f32 v19, v19, v23
    s_nop 0
    v_permlane16_swap_b32 v16, v18
    v_permlane16_swap_b32 v17, v19
    v_add_f32 v16, v16, v18
    v_add_f32 v17, v17, v19
    s_nop 0
    v_add_f32_dpp v3, v16, v16 row_ror:8 row_mask:0xf bank_mask:0x3
    s_nop 1
    v_add_f32_dpp v3, v17, v17 row_ror:8 row_mask:0xf bank_mask:0xc
    ds_write_b32 v11, v3 offset:4096
    v_mov_b32 v3, 1
    s_mov_b64 exec, 1
    ds_add_rtn_u32 v3, v7, v3 offset:16
    s_mov_b64 exec, -1
    s_waitcnt lgkmcnt(0)
    v_readfirstlane_b32 s37, v3
    s_nop 0
    s_cmp_lg_u32 s37, 3
    s_cbranch_scc1 L_la_99
    ds_read_b32 v12, v152 offset:4096
    ds_read_b32 v13, v152 offset:4352
    ds_read_b32 v14, v152 offset:4608
    ds_read_b32 v15, v152 offset:4864
    s_waitcnt lgkmcnt(0)
    v_add_f32 v12, v12, v13
    v_add_f32 v14, v14, v15
    v_add_f32 v12, v12, v14
    v_min_u32 v12, -2, v12
    s_add_u32 s37, s46, 0x30000
    buffer_store_dword v12, v152, s[12:15], s37 offen sc1
L_la_99:
    s_cmp_lg_u32 s49, s44
    s_cbranch_scc1 L_nomk2
    s_lshl_b32 s37, s48, 1
    buffer_load_dwordx2 v[36:37], v2, s[24:27], s37 offen
    buffer_load_dwordx2 v[38:39], v2, s[24:27], s37 offen offset:64
    s_mul_i32 s36, s48, 12288
    s_add_u32 s36, s36, s45
    s_add_u32 s36, s36, 4096
    s_add_u32 s37, s36, 0
    s_waitcnt vmcnt(5)
    buffer_load_dwordx4 v[120:123], v1, s[16:19], s37 offen nt
    s_add_u32 s37, s36, 12288
    s_waitcnt vmcnt(5)
    buffer_load_dwordx4 v[124:127], v1, s[16:19], s37 offen nt
    s_add_u32 s37, s36, 24576
    s_waitcnt vmcnt(5)
    buffer_load_dwordx4 v[128:131], v1, s[16:19], s37 offen nt
    s_add_u32 s37, s36, 36864
    s_waitcnt vmcnt(5)
    buffer_load_dwordx4 v[132:135], v1, s[16:19], s37 offen nt
    s_add_u32 s37, s36, 393216
    s_waitcnt vmcnt(3)
    buffer_load_dwordx4 v[136:139], v1, s[16:19], s37 offen nt
    s_add_u32 s37, s36, 405504
    s_waitcnt vmcnt(3)
    buffer_load_dwordx4 v[140:143], v1, s[16:19], s37 offen nt
    s_add_u32 s37, s36, 417792
    s_waitcnt vmcnt(3)
    buffer_load_dwordx4 v[144:147], v1, s[16:19], s37 offen nt
    s_add_u32 s37, s36, 430080
    s_waitcnt vmcnt(3)
    buffer_load_dwordx4 v[148:151], v1, s[16:19], s37 offen nt
    s_waitcnt vmcnt(8)
    v_lshlrev_b32 v16, 16, v36
    v_and_b32 v17, 0xffff0000, v36
    v_lshlrev_b32 v18, 16, v37
    v_and_b32 v19, 0xffff0000, v37
    v_mul_f32 v20, 0xbfb8aa3b, v16
    v_mul_f32 v21, 0xbfb8aa3b, v17
    v_mul_f32 v22, 0xbfb8aa3b, v18
    v_mul_f32 v23, 0xbfb8aa3b, v19
    v_exp_f32 v20, v20
    v_exp_f32 v21, v21
    v_exp_f32 v22, v22
    v_exp_f32 v23, v23
    v_max_f32 v16, 0xc3000000, v16
    v_max_f32 v17, 0xc3000000, v17
    v_max_f32 v18, 0xc3000000, v18
    v_max_f32 v19, 0xc3000000, v19
    v_add_f32 v20, 1.0, v20
    v_add_f32 v21, 1.0, v21
    v_add_f32 v22, 1.0, v22
    v_add_f32 v23, 1.0, v23
    v_min_f32 v20, 0x7e800000, v20
    v_min_f32 v21, 0x7e800000, v21
    v_min_f32 v22, 0x7e800000, v22
    v_min_f32 v23, 0x7e800000, v23
    v_rcp_f32 v24, v20
    v_rcp_f32 v25, v21
    v_rcp_f32 v26, v22
    v_rcp_f32 v27, v23
    v_mul_f32 v28, v16, v24
    v_mul_f32 v29, v17, v25
    v_mul_f32 v30, v18, v26
    v_mul_f32 v31, v19, v27
    v_fma_f32 v20, -v28, v20, v16
    v_fma_f32 v21, -v29, v21, v17
    v_fma_f32 v22, -v30, v22, v18
    v_fma_f32 v23, -v31, v23, v19
    v_fma_f32 v16, v20, v24, v28
    v_fma_f32 v17, v21, v25, v29
    v_fma_f32 v18, v22, v26, v30
    v_fma_f32 v19, v23, v27, v31
    v_cvt_pk_bf16_f32 v36, v16, v17
    v_cvt_pk_bf16_f32 v37, v18, v19
    v_lshlrev_b32 v16, 16, v38
    v_and_b32 v17, 0xffff0000, v38
    v_lshlrev_b32 v18, 16, v39
    v_and_b32 v19, 0xffff0000, v39
    v_mul_f32 v20, 0xbfb8aa3b, v16
    v_mul_f32 v21, 0xbfb8aa3b, v17
    v_mul_f32 v22, 0xbfb8aa3b, v18
    v_mul_f32 v23, 0xbfb8aa3b, v19
    v_exp_f32 v20, v20
    v_exp_f32 v21, v21
    v_exp_f32 v22, v22
    v_exp_f32 v23, v23
    v_max_f32 v16, 0xc3000000, v16
    v_max_f32 v17, 0xc3000000, v17
    v_max_f32 v18, 0xc3000000, v18
    v_max_f32 v19, 0xc3000000, v19
    v_add_f32 v20, 1.0, v20
    v_add_f32 v21, 1.0, v21
    v_add_f32 v22, 1.0, v22
    v_add_f32 v23, 1.0, v23
    v_min_f32 v20, 0x7e800000, v20
    v_min_f32 v21, 0x7e800000, v21
    v_min_f32 v22, 0x7e800000, v22
    v_min_f32 v23, 0x7e800000, v23
    v_rcp_f32 v24, v20
    v_rcp_f32 v25, v21
    v_rcp_f32 v26, v22
    v_rcp_f32 v27, v23
    v_mul_f32 v28, v16, v24
    v_mul_f32 v29, v17, v25
    v_mul_f32 v30, v18, v26
    v_mul_f32 v31, v19, v27
    v_fma_f32 v20, -v28, v20, v16
    v_fma_f32 v21, -v29, v21, v17
    v_fma_f32 v22, -v30, v22, v18
    v_fma_f32 v23, -v31, v23, v19
    v_fma_f32 v16, v20, v24, v28
    v_fma_f32 v17, v21, v25, v29
    v_fma_f32 v18, v22, v26, v30
    v_fma_f32 v19, v23, v27, v31
    v_cvt_pk_bf16_f32 v38, v16, v17
    v_cvt_pk_bf16_f32 v39, v18, v19
    s_waitcnt vmcnt(4)
    v_perm_b32 v40, v124, v120, s32
    v_perm_b32 v41, v124, v120, s33
    v_perm_b32 v42, v125, v121, s32
    v_perm_b32 v43, v125, v121, s33
    v_perm_b32 v44, v126, v122, s32
    v_perm_b32 v45, v126, v122, s33
    v_perm_b32 v46, v127, v123, s32
    v_perm_b32 v47, v127, v123, s33
    v_perm_b32 v48, v132, v128, s32
    v_perm_b32 v49, v132, v128, s33
    v_perm_b32 v50, v133, v129, s32
    v_perm_b32 v51, v133, v129, s33
    v_perm_b32 v52, v134, v130, s32
    v_perm_b32 v53, v134, v130, s33
    v_perm_b32 v54, v135, v131, s32
    v_perm_b32 v55, v135, v131, s33
    v_dot2_f32_bf16 v16, v40, v36, 0
    v_dot2_f32_bf16 v17, v41, v36, 0
    v_dot2_f32_bf16 v18, v42, v36, 0
    v_dot2_f32_bf16 v19, v43, v36, 0
    v_dot2_f32_bf16 v20, v44, v36, 0
    v_dot2_f32_bf16 v21, v45, v36, 0
    v_dot2_f32_bf16 v22, v46, v36, 0
    v_dot2_f32_bf16 v23, v47, v36, 0
    v_dot2_f32_bf16 v16, v48, v37, v16
    v_dot2_f32_bf16 v17, v49, v37, v17
    v_dot2_f32_bf16 v18, v50, v37, v18
    v_dot2_f32_bf16 v19, v51, v37, v19
    v_dot2_f32_bf16 v20, v52, v37, v20
    v_dot2_f32_bf16 v21, v53, v37, v21
    v_dot2_f32_bf16 v22, v54, v37, v22
    v_dot2_f32_bf16 v23, v55, v37, v23
    s_waitcnt vmcnt(0)
    v_perm_b32 v40, v140, v136, s32
    v_perm_b32 v41, v140, v136, s33
    v_perm_b32 v42, v141, v137, s32
    v_perm_b32 v43, v141, v137, s33
    v_perm_b32 v44, v142, v138, s32
    v_perm_b32 v45, v142, v138, s33
    v_perm_b32 v46, v143, v139, s32
    v_perm_b32 v47, v143, v139, s33
    v_perm_b32 v48, v148, v144, s32
    v_perm_b32 v49, v148, v144, s33
    v_perm_b32 v50, v149, v145, s32
    v_perm_b32 v51, v149, v145, s33
    v_perm_b32 v52, v150, v146, s32
    v_perm_b32 v53, v150, v146, s33
    v_perm_b32 v54, v151, v147, s32
    v_perm_b32 v55, v151, v147, s33
    v_dot2_f32_bf16 v16, v40, v38, v16
    v_dot2_f32_bf16 v17, v41, v38, v17
    v_dot2_f32_bf16 v18, v42, v38, v18
    v_dot2_f32_bf16 v19, v43, v38, v19
    v_dot2_f32_bf16 v20, v44, v38, v20
    v_dot2_f32_bf16 v21, v45, v38, v21
    v_dot2_f32_bf16 v22, v46, v38, v22
    v_dot2_f32_bf16 v23, v47, v38, v23
    v_dot2_f32_bf16 v16, v48, v39, v16
    v_dot2_f32_bf16 v17, v49, v39, v17
    v_dot2_f32_bf16 v18, v50, v39, v18
    v_dot2_f32_bf16 v19, v51, v39, v19
    v_dot2_f32_bf16 v20, v52, v39, v20
    v_dot2_f32_bf16 v21, v53, v39, v21
    v_dot2_f32_bf16 v22, v54, v39, v22
    v_dot2_f32_bf16 v23, v55, v39, v23
    v_permlane32_swap_b32 v16, v20
    v_permlane32_swap_b32 v17, v21
    v_permlane32_swap_b32 v18, v22
    v_permlane32_swap_b32 v19, v23
    v_add_f32 v16, v16, v20
    v_add_f32 v17, v17, v21
    v_add_f32 v18, v18, v22
    v_add_f32 v19, v19, v23
    s_nop 0
    v_permlane16_swap_b32 v16, v18
    v_permlane16_swap_b32 v17, v19
    v_add_f32 v16, v16, v18
    v_add_f32 v17, v17, v19
    s_nop 0
    v_add_f32_dpp v3, v16, v16 row_ror:8 row_mask:0xf bank_mask:0x3
    s_nop 1
    v_add_f32_dpp v3, v17, v17 row_ror:8 row_mask:0xf bank_mask:0xc
    ds_write_b32 v11, v3 offset:5120
    v_mov_b32 v3, 1
    s_mov_b64 exec, 1
    ds_add_rtn_u32 v3, v7, v3 offset:20
    s_mov_b64 exec, -1
    s_waitcnt lgkmcnt(0)
    v_readfirstlane_b32 s37, v3
    s_nop 0
    s_cmp_lg_u32 s37, 3
    s_cbranch_scc1 L_la_100
    ds_read_b32 v12, v152 offset:5120
    ds_read_b32 v13, v152 offset:5376
    ds_read_b32 v14, v152 offset:5632
    ds_read_b32 v15, v152 offset:5888
    s_waitcnt lgkmcnt(0)
    v_add_f32 v12, v12, v13
    v_add_f32 v14, v14, v15
    v_add_f32 v12, v12, v14
    v_min_u32 v12, -2, v12
    s_add_u32 s37, s46, 0x40000
    buffer_store_dword v12, v152, s[12:15], s37 offen sc1
L_la_100:
L_nomk2:
    s_lshl_b32 s38, s51, 10
    s_add_u32 s38, s38, 0x30000
    v_and_b32 v9, 15, v0
    v_lshlrev_b32 v9, 2, v9
    v_lshrrev_b32 v3, 4, v0
    v_add_u32 v9, v9, v3
    v_lshlrev_b32 v9, 1, v9
    s_lshl_b32 s37, s3, 9
    v_add_u32 v9, s37, v9
    s_mov_b32 s59, 0
L_sp_101:
    ds_read_b32 v3, v7 offset:28
    s_waitcnt lgkmcnt(0)
    v_cmp_gt_u32 vcc, 1, v3
    s_cbranch_vccz L_spx_102
    s_sleep 4
    s_add_u32 s59, s59, 1
    s_cmp_lt_u32 s59, 0x800000
    s_cbranch_scc1 L_sp_101
L_spx_102:
    s_mov_b32 s59, 0
L_g_103:
    buffer_load_dwordx4 v[56:59], v4, s[12:15], s38 offen offset:0 sc1
    buffer_load_dwordx4 v[60:63], v4, s[12:15], s38 offen offset:1024 sc1
    buffer_load_dwordx4 v[64:67], v4, s[12:15], s38 offen offset:2048 sc1
    buffer_load_dwordx4 v[68:71], v4, s[12:15], s38 offen offset:3072 sc1
    s_waitcnt vmcnt(0)
    v_max_u32 v16, v56, v57
    v_max3_u32 v16, v16, v58, v59
    v_max3_u32 v16, v16, v60, v61
    v_max3_u32 v16, v16, v62, v63
    v_max3_u32 v16, v16, v64, v65
    v_max3_u32 v16, v16, v66, v67
    v_max3_u32 v16, v16, v68, v69
    v_max3_u32 v16, v16, v70, v71
    v_cmp_eq_u32 vcc, -1, v16
    s_cbranch_vccz L_gx_104
    s_sleep 8
    s_add_u32 s59, s59, 1
    s_cmp_lt_u32 s59, 0x100000
    s_cbranch_scc1 L_g_103
L_gx_104:
    v_permlane32_swap_b32 v56, v58
    v_permlane32_swap_b32 v57, v59
    v_add_f32 v56, v56, v58
    v_add_f32 v57, v57, v59
    s_nop 1
    v_permlane16_swap_b32 v56, v57
    v_add_f32 v56, v56, v57
    v_cvt_pk_bf16_f32 v56, v56, v56
    ds_write_b16 v9, v56 offset:6144
    v_permlane32_swap_b32 v60, v62
    v_permlane32_swap_b32 v61, v63
    v_add_f32 v60, v60, v62
    v_add_f32 v61, v61, v63
    s_nop 1
    v_permlane16_swap_b32 v60, v61
    v_add_f32 v60, v60, v61
    v_cvt_pk_bf16_f32 v60, v60, v60
    ds_write_b16 v9, v60 offset:6272
    v_permlane32_swap_b32 v64, v66
    v_permlane32_swap_b32 v65, v67
    v_add_f32 v64, v64, v66
    v_add_f32 v65, v65, v67
    s_nop 1
    v_permlane16_swap_b32 v64, v65
    v_add_f32 v64, v64, v65
    v_cvt_pk_bf16_f32 v64, v64, v64
    ds_write_b16 v9, v64 offset:6400
    v_permlane32_swap_b32 v68, v70
    v_permlane32_swap_b32 v69, v71
    v_add_f32 v68, v68, v70
    v_add_f32 v69, v69, v71
    s_nop 1
    v_permlane16_swap_b32 v68, v69
    v_add_f32 v68, v68, v69
    v_cvt_pk_bf16_f32 v68, v68, v68
    ds_write_b16 v9, v68 offset:6528
    v_mov_b32 v3, 1
    s_mov_b64 exec, 1
    ds_add_u32 v7, v3 offset:0
    s_mov_b64 exec, -1
    s_mov_b32 s57, s56
    s_and_b32 s51, s2, 7
    s_mul_i32 s51, s51, 28
    s_lshr_b32 s37, s2, 3
    s_add_u32 s51, s51, s37
    s_sub_u32 s52, s2, 224
    v_and_b32 v160, 7, v0
    v_lshlrev_b32 v160, 2, v160
    v_lshrrev_b32 v3, 4, v0
    v_add_u32 v160, v160, v3
    v_lshlrev_b32 v161, 1, v160
    v_lshlrev_b32 v162, 2, v160
    s_lshl_b32 s37, s3, 7
    v_add_u32 v160, s37, v162
    v_lshrrev_b32 v158, 4, v0
    v_and_b32 v165, 1, v158
    v_lshlrev_b32 v165, 10, v165
    v_and_b32 v3, 15, v0
    v_lshl_add_u32 v165, v3, 4, v165
    s_lshl_b32 s37, s3, 2
    v_add_u32 v158, s37, v158
    v_mul_u32_u24 v158, 272, v158
    v_lshl_add_u32 v158, v3, 4, v158
    v_lshrrev_b32 v154, 2, v0
    v_lshlrev_b32 v154, 7, v154
    v_and_b32 v3, 3, v0
    v_lshl_add_u32 v154, v3, 4, v154
    v_lshrrev_b32 v159, 3, v0
    v_lshlrev_b32 v159, 12, v159
    v_and_b32 v3, 7, v0
    v_lshl_add_u32 v159, v3, 4, v159
    s_and_b32 s49, s2, 7
    s_lshr_b32 s48, s2, 3
    s_lshl_b32 s53, s49, 17
    s_add_u32 s54, s53, 0x300000
    s_lshl_b32 s37, s3, 8
    s_add_u32 s37, s37, s48
    s_lshl_b32 s37, s37, 7
    s_add_u32 s53, s54, s37
    s_bfe_u32 s46, s52, 0x20003
    s_lshl_b32 s46, s46, 2
    s_add_u32 s46, s46, s3
    s_lshl_b32 s37, s46, 13
    s_add_u32 s54, s54, s37
    s_lshl_b32 s50, s47, 4
    s_add_u32 s50, s50, s46
    s_sub_u32 s50, s50, s3
    s_lshl_b32 s50, s50, 2
    s_and_b32 s37, s2, 1
    s_add_u32 s50, s50, s37
    s_lshl_b32 s50, s50, 7
    s_add_u32 s50, s50, 0xb0000
    s_lshl_b32 s37, s47, 13
    s_add_u32 s50, s50, s37
    s_mov_b32 s36, 0
    s_lshl_b32 s36, s36, 13
    s_add_u32 s36, s36, 0xa8000
    s_bfe_u32 s52, s52, 0x20003
    s_lshl_b32 s37, s49, 2
    s_add_u32 s52, s52, s37
    v_lshlrev_b32 v164, 3, v0
    v_and_b32 v157, -4, v161
    v_bfe_u32 v166, v0, 3, 1
    v_lshl_add_u32 v163, v166, 7, v162
    s_lshl_b32 s37, s3, 8
    v_add_u32 v163, s37, v163
    v_lshl_add_u32 v166, v166, 6, v157
    s_add_u32 s22, s54, 4096
    s_lshl_b32 s16, s49, 4
    s_add_u32 s16, s16, s46
    s_lshl_b32 s16, s16, 12
    s_add_u32 s16, s16, 0x200000
    s_lshl_b32 s17, s52, 15
    s_lshl_b32 s37, s3, 10
    s_add_u32 s17, s17, s37
    s_mov_b32 s37, 0
    s_lshl_b32 s37, s37, 13
    s_add_u32 s17, s17, s37
    s_add_u32 s17, s17, 0x100000
    s_add_u32 s18, s17, 4096
    s_add_u32 s19, s17, 0x4000
    s_add_u32 s20, s17, 0x5000
    s_cmp_lt_u32 s3, 2
    s_cselect_b32 s20, s20, s19
    s_lshl_b32 s24, s52, 7
    s_add_u32 s24, s24, 0xa8000
    v_bfe_u32 v3, v0, 4, 1
    v_lshl_add_u32 v31, v3, 6, v157
    v_add_u32 v31, 0x1000, v31
    v_lshrrev_b32 v3, 4, v0
    v_lshlrev_b32 v3, 2, v3
    s_nop 1
    v_mov_b32_dpp v31, v3 quad_perm:[0,1,2,3] row_mask:0xf bank_mask:0xc
    v_lshrrev_b32 v30, 1, v0
    v_lshlrev_b32 v30, 7, v30
    v_and_b32 v3, 1, v0
    v_lshl_add_u32 v30, v3, 3, v30
    v_lshrrev_b32 v28, 3, v0
    v_and_b32 v3, 7, v0
    v_lshlrev_b32 v3, 4, v3
    v_lshl_add_u32 v29, v28, 8, v3
    s_cmp_lt_u32 s2, 224
    s_cbranch_scc1 L_nored0
    s_lshl_b32 s37, s52, 6
    buffer_load_ushort v167, v161, s[28:31], s37 offen
    s_lshr_b32 s38, s52, 1
    s_lshl_b32 s38, s38, 10
    s_and_b32 s37, s52, 1
    s_lshl_b32 s37, s37, 7
    s_add_u32 s38, s38, s37
    s_add_u32 s38, s38, 0x40000
    s_add_u32 s39, s38, 0x8000
    s_add_u32 s40, s38, 0xc000
    v_and_b32 v3, 0x37, v0
    v_lshlrev_b32 v3, 4, v3
    s_mov_b32 s59, 0
L_g_105:
    buffer_load_dwordx4 v[120:123], v3, s[12:15], s38 offen sc1
    buffer_load_dwordx4 v[124:127], v3, s[12:15], s39 offen sc1
    buffer_load_dwordx4 v[128:131], v3, s[12:15], s40 offen sc1
    s_waitcnt vmcnt(0)
    v_max_u32 v16, v120, v121
    v_max3_u32 v16, v16, v122, v123
    v_max3_u32 v16, v16, v124, v125
    v_max3_u32 v16, v16, v126, v127
    v_max3_u32 v16, v16, v128, v129
    v_max3_u32 v16, v16, v130, v131
    v_cmp_eq_u32 vcc, -1, v16
    s_cbranch_vccz L_gx_106
    s_sleep 8
    s_add_u32 s59, s59, 1
    s_cmp_lt_u32 s59, 0x100000
    s_cbranch_scc1 L_g_105
L_gx_106:
    v_permlane32_swap_b32 v120, v122
    v_permlane32_swap_b32 v121, v123
    v_add_f32 v120, v120, v122
    v_add_f32 v121, v121, v123
    s_nop 1
    v_permlane16_swap_b32 v120, v121
    v_add_f32 v120, v120, v121
    v_permlane32_swap_b32 v124, v126
    v_permlane32_swap_b32 v125, v127
    v_add_f32 v124, v124, v126
    v_add_f32 v125, v125, v127
    s_nop 1
    v_permlane16_swap_b32 v124, v125
    v_add_f32 v124, v124, v125
    v_permlane32_swap_b32 v128, v130
    v_permlane32_swap_b32 v129, v131
    v_add_f32 v128, v128, v130
    v_add_f32 v129, v129, v131
    s_nop 1
    v_permlane16_swap_b32 v128, v129
    v_add_f32 v128, v128, v129
    v_cvt_pk_bf16_f32 v155, v120, v120
    v_lshlrev_b32 v155, 16, v155
    v_cvt_pk_bf16_f32 v156, v128, v128
    v_lshlrev_b32 v156, 16, v156
    v_cvt_pk_bf16_f32 v32, v124, v124
    v_lshlrev_b32 v32, 16, v32
    v_add_f32 v32, 1.0, v32
    v_cvt_pk_bf16_f32 v32, v32, v32
    v_lshlrev_b32 v32, 16, v32
    v_mov_b32 v33, v32
    s_nop 1
    v_permlane16_swap_b32 v32, v33
    v_lshlrev_b32 v167, 16, v167
L_nored0:
    s_cmp_eq_u32 s3, 0
    s_cbranch_scc1 L_ml
    s_cmp_eq_u32 s3, 3
    s_cbranch_scc1 L_beacon
    s_cmp_eq_u32 s3, 1
    s_cbranch_scc1 L_xcc
    s_cmp_ge_u32 s2, 224
    s_cbranch_scc1 L_vdone
    s_bitcmp1_b32 s2, 3
    s_cbranch_scc1 L_vdone
    s_lshr_b32 s38, s2, 4
    s_mul_i32 s38, s38, 1176
    s_and_b32 s38, s38, 0xfc00
    s_add_u32 s38, s38, 0x44000
    s_add_u32 s39, s38, 0x4000
    s_mov_b32 s59, 0
L_g_107:
    buffer_load_dwordx4 v[120:123], v165, s[12:15], s38 offen offset:0 sc1
    buffer_load_dwordx4 v[124:127], v165, s[12:15], s38 offen offset:256 sc1
    buffer_load_dwordx4 v[128:131], v165, s[12:15], s38 offen offset:512 sc1
    buffer_load_dwordx4 v[132:135], v165, s[12:15], s38 offen offset:768 sc1
    buffer_load_dwordx4 v[136:139], v165, s[12:15], s39 offen offset:0 sc1
    buffer_load_dwordx4 v[140:143], v165, s[12:15], s39 offen offset:256 sc1
    buffer_load_dwordx4 v[144:147], v165, s[12:15], s39 offen offset:512 sc1
    buffer_load_dwordx4 v[148:151], v165, s[12:15], s39 offen offset:768 sc1
    s_waitcnt vmcnt(0)
    v_max_u32 v16, v120, v121
    v_max3_u32 v16, v16, v122, v123
    v_max3_u32 v16, v16, v124, v125
    v_max3_u32 v16, v16, v126, v127
    v_max3_u32 v16, v16, v128, v129
    v_max3_u32 v16, v16, v130, v131
    v_max3_u32 v16, v16, v132, v133
    v_max3_u32 v16, v16, v134, v135
    v_max3_u32 v16, v16, v136, v137
    v_max3_u32 v16, v16, v138, v139
    v_max3_u32 v16, v16, v140, v141
    v_max3_u32 v16, v16, v142, v143
    v_max3_u32 v16, v16, v144, v145
    v_max3_u32 v16, v16, v146, v147
    v_max3_u32 v16, v16, v148, v149
    v_max3_u32 v16, v16, v150, v151
    v_cmp_eq_u32 vcc, -1, v16
    s_cbranch_vccz L_gx_108
    s_sleep 8
    s_add_u32 s59, s59, 1
    s_cmp_lt_u32 s59, 0x100000
    s_cbranch_scc1 L_g_107
L_gx_108:
    v_pk_add_f32 v[120:121], v[120:121], v[124:125]
    v_pk_add_f32 v[122:123], v[122:123], v[126:127]
    v_pk_add_f32 v[128:129], v[128:129], v[132:133]
    v_pk_add_f32 v[130:131], v[130:131], v[134:135]
    v_pk_add_f32 v[40:41], v[120:121], v[128:129]
    v_pk_add_f32 v[42:43], v[122:123], v[130:131]
    v_pk_add_f32 v[136:137], v[136:137], v[140:141]
    v_pk_add_f32 v[138:139], v[138:139], v[142:143]
    v_pk_add_f32 v[144:145], v[144:145], v[148:149]
    v_pk_add_f32 v[146:147], v[146:147], v[150:151]
    v_pk_add_f32 v[44:45], v[136:137], v[144:145]
    v_pk_add_f32 v[46:47], v[138:139], v[146:147]
    v_cvt_pk_bf16_f32 v44, v44, v44
    v_lshlrev_b32 v44, 16, v44
    v_cvt_pk_bf16_f32 v45, v45, v45
    v_lshlrev_b32 v45, 16, v45
    v_cvt_pk_bf16_f32 v46, v46, v46
    v_lshlrev_b32 v46, 16, v46
    v_cvt_pk_bf16_f32 v47, v47, v47
    v_lshlrev_b32 v47, 16, v47
    v_add_f32 v44, 1.0, v44
    v_add_f32 v45, 1.0, v45
    v_add_f32 v46, 1.0, v46
    v_add_f32 v47, 1.0, v47
    v_cvt_pk_bf16_f32 v40, v40, v41
    v_cvt_pk_bf16_f32 v41, v42, v43
    v_cvt_pk_bf16_f32 v44, v44, v45
    v_cvt_pk_bf16_f32 v45, v46, v47
    v_min_u32 v40, -2, v40
    v_min_u32 v41, -2, v41
    v_min_u32 v44, -2, v44
    v_min_u32 v45, -2, v45
    v_and_b32 v3, 0x18, v0
    v_and_b32 v16, 0xff, v164
    v_lshl_add_u32 v3, v3, 3, v16
    ds_write_b64 v3, v[44:45] offset:2048
    ds_write_b64 v3, v[40:41] offset:2112
    v_mov_b32 v3, 1
    s_mov_b64 exec, 1
    ds_add_u32 v7, v3 offset:48
    s_mov_b64 exec, -1
    s_branch L_vdone
L_xcc:
    s_lshl_b32 s38, s49, 7
    s_mov_b32 s39, 0
    s_mov_b32 s40, 0
    s_load_dwordx16 s[60:75], s[12:13], s38 offset:0x9000 glc
    s_waitcnt lgkmcnt(0)
    s_xor_b32 s37, s60, s11
    s_or_b32 s39, s39, s37
    s_add_u32 s40, s40, s37
    s_xor_b32 s37, s61, s11
    s_or_b32 s39, s39, s37
    s_add_u32 s40, s40, s37
    s_xor_b32 s37, s62, s11
    s_or_b32 s39, s39, s37
    s_add_u32 s40, s40, s37
    s_xor_b32 s37, s63, s11
    s_or_b32 s39, s39, s37
    s_add_u32 s40, s40, s37
    s_xor_b32 s37, s64, s11
    s_or_b32 s39, s39, s37
    s_add_u32 s40, s40, s37
    s_xor_b32 s37, s65, s11
    s_or_b32 s39, s39, s37
    s_add_u32 s40, s40, s37
    s_xor_b32 s37, s66, s11
    s_or_b32 s39, s39, s37
    s_add_u32 s40, s40, s37
    s_xor_b32 s37, s67, s11
    s_or_b32 s39, s39, s37
    s_add_u32 s40, s40, s37
    s_xor_b32 s37, s68, s11
    s_or_b32 s39, s39, s37
    s_add_u32 s40, s40, s37
    s_xor_b32 s37, s69, s11
    s_or_b32 s39, s39, s37
    s_add_u32 s40, s40, s37
    s_xor_b32 s37, s70, s11
    s_or_b32 s39, s39, s37
    s_add_u32 s40, s40, s37
    s_xor_b32 s37, s71, s11
    s_or_b32 s39, s39, s37
    s_add_u32 s40, s40, s37
    s_xor_b32 s37, s72, s11
    s_or_b32 s39, s39, s37
    s_add_u32 s40, s40, s37
    s_xor_b32 s37, s73, s11
    s_or_b32 s39, s39, s37
    s_add_u32 s40, s40, s37
    s_xor_b32 s37, s74, s11
    s_or_b32 s39, s39, s37
    s_add_u32 s40, s40, s37
    s_xor_b32 s37, s75, s11
    s_or_b32 s39, s39, s37
    s_add_u32 s40, s40, s37
    s_load_dwordx16 s[60:75], s[12:13], s38 offset:0x9040 glc
    s_waitcnt lgkmcnt(0)
    s_xor_b32 s37, s60, s11
    s_or_b32 s39, s39, s37
    s_add_u32 s40, s40, s37
    s_xor_b32 s37, s61, s11
    s_or_b32 s39, s39, s37
    s_add_u32 s40, s40, s37
    s_xor_b32 s37, s62, s11
    s_or_b32 s39, s39, s37
    s_add_u32 s40, s40, s37
    s_xor_b32 s37, s63, s11
    s_or_b32 s39, s39, s37
    s_add_u32 s40, s40, s37
    s_xor_b32 s37, s64, s11
    s_or_b32 s39, s39, s37
    s_add_u32 s40, s40, s37
    s_xor_b32 s37, s65, s11
    s_or_b32 s39, s39, s37
    s_add_u32 s40, s40, s37
    s_xor_b32 s37, s66, s11
    s_or_b32 s39, s39, s37
    s_add_u32 s40, s40, s37
    s_xor_b32 s37, s67, s11
    s_or_b32 s39, s39, s37
    s_add_u32 s40, s40, s37
    s_xor_b32 s37, s68, s11
    s_or_b32 s39, s39, s37
    s_add_u32 s40, s40, s37
    s_xor_b32 s37, s69, s11
    s_or_b32 s39, s39, s37
    s_add_u32 s40, s40, s37
    s_xor_b32 s37, s70, s11
    s_or_b32 s39, s39, s37
    s_add_u32 s40, s40, s37
    s_xor_b32 s37, s71, s11
    s_or_b32 s39, s39, s37
    s_add_u32 s40, s40, s37
    s_xor_b32 s37, s72, s11
    s_or_b32 s39, s39, s37
    s_add_u32 s40, s40, s37
    s_xor_b32 s37, s73, s11
    s_or_b32 s39, s39, s37
    s_add_u32 s40, s40, s37
    s_xor_b32 s37, s74, s11
    s_or_b32 s39, s39, s37
    s_add_u32 s40, s40, s37
    s_xor_b32 s37, s75, s11
    s_or_b32 s39, s39, s37
    s_add_u32 s40, s40, s37
    s_cmp_gt_u32 s40, 1024
    s_cselect_b32 s37, 7, 3
    s_cmp_lt_u32 s39, 64
    s_cselect_b32 s37, s37, 1
    v_mov_b32 v3, s37
    ds_write_b32 v7, v3 offset:44
    s_branch L_vdone
L_beacon:
    s_cmp_lt_u32 s2, 224
    s_cbranch_scc1 L_bgo
    v_mov_b32 v3, 200
    s_mov_b64 exec, 1
    ds_add_u32 v7, v3 offset:60
    s_mov_b64 exec, -1
    s_branch L_vdone
L_bgo:
    s_lshl_b32 s38, s49, 7
    s_add_u32 s38, s38, 0x80000
    s_lshl_b32 s44, s48, 2
    s_add_u32 s44, s44, s38
    s_lshl_b32 s39, s34, 16
    s_mov_b32 s40, 0
    s_mov_b32 s41, -1
    s_bitcmp1_b32 s2, 3
    s_cselect_b32 s43, 0, 0
    s_mov_b32 s59, 0x100000
    s_mov_b32 exec_hi, 0
L_bl:
    ds_read_b32 v3, v7 offset:60
    s_waitcnt lgkmcnt(0)
    v_readfirstlane_b32 s42, v3
    s_nop 0
    s_sub_u32 s42, s42, s40
    s_or_b32 s37, s42, s39
    v_mov_b32 v3, s37
    s_mov_b32 exec_lo, 1
    buffer_store_dword v3, v7, s[12:15], s44 offen
    s_mov_b32 exec_lo, 0x1fffffff
    s_cmp_ge_u32 s42, 496
    s_cbranch_scc1 L_bx
    buffer_load_dword v20, v152, s[12:15], s38 offen sc1
    s_min_u32 s41, s41, s42
    s_add_u32 s41, s41, s42
    s_lshr_b32 s41, s41, 1
    v_mov_b32 v21, s41
    s_waitcnt vmcnt(0)
    v_xor_b32 v20, s39, v20
    v_cmp_gt_u32 vcc, 0x400, v20
    s_nop 1
    v_cndmask_b32 v20, v21, v20, vcc
    v_sub_u32 v20, v20, v21
    s_mov_b32 exec_lo, 0xf0000000
    v_mov_b32 v20, 0
    s_mov_b32 exec_lo, -1
    s_nop 0
    v_add_u32_dpp v20, v20, v20 row_ror:8 row_mask:0xf bank_mask:0xf
    s_nop 1
    v_add_u32_dpp v20, v20, v20 row_ror:4 row_mask:0xf bank_mask:0xf
    s_nop 1
    v_add_u32_dpp v20, v20, v20 row_ror:2 row_mask:0xf bank_mask:0xf
    s_nop 1
    v_add_u32_dpp v20, v20, v20 row_ror:1 row_mask:0xf bank_mask:0xf
    s_nop 0
    v_readlane_b32 s37, v20, 0
    v_readlane_b32 s45, v20, 16
    s_nop 0
    s_add_u32 s37, s37, s45
    s_mul_i32 s37, s37, 37
    s_ashr_i32 s37, s37, 10
    s_add_u32 s37, s37, s43
    s_sub_u32 s45, s37, s40
    s_mov_b32 s40, s37
    s_mov_b32 s41, s42
    v_mov_b32 v3, s45
    s_mov_b32 exec_lo, 1
    ds_add_u32 v7, v3 offset:60
    s_sub_u32 s59, s59, 1
    s_cbranch_scc0 L_bl
L_bx:
    s_mov_b64 exec, -1
    s_branch L_vdone
L_ml:
    v_lshlrev_b32 v8, 6, v0
    s_mov_b32 s59, 0
L_sp_109:
    ds_read_b32 v3, v7 offset:4
    s_waitcnt lgkmcnt(0)
    v_cmp_gt_u32 vcc, 8, v3
    s_cbranch_vccz L_spx_110
    s_sleep 2
    s_add_u32 s59, s59, 1
    s_cmp_lt_u32 s59, 0x800000
    s_cbranch_scc1 L_sp_109
L_spx_110:
    ds_read_b128 v[120:123], v8 offset:8192
    ds_read_b128 v[124:127], v8 offset:8208
    ds_read_b128 v[128:131], v8 offset:8224
    ds_read_b128 v[132:135], v8 offset:8240
    s_waitcnt lgkmcnt(0)
    v_max3_f32 v16, v120, v122, v124
    v_max3_f32 v16, v16, v126, v128
    v_max3_f32 v16, v16, v130, v132
    v_max_f32 v16, v16, v134
    s_nop 1
    v_max_f32_dpp v16, v16, v16 quad_perm:[1,0,3,2] row_mask:0xf bank_mask:0xf
    s_nop 1
    v_max_f32_dpp v16, v16, v16 quad_perm:[2,3,0,1] row_mask:0xf bank_mask:0xf
    s_nop 1
    v_max_f32_dpp v16, v16, v16 row_half_mirror row_mask:0xf bank_mask:0xf
    v_sub_f32 v120, v120, v16
    v_sub_f32 v122, v122, v16
    v_sub_f32 v124, v124, v16
    v_sub_f32 v126, v126, v16
    v_sub_f32 v128, v128, v16
    v_sub_f32 v130, v130, v16
    v_sub_f32 v132, v132, v16
    v_sub_f32 v134, v134, v16
    v_mul_f32 v120, 0x3fb8aa3b, v120
    v_mul_f32 v122, 0x3fb8aa3b, v122
    v_mul_f32 v124, 0x3fb8aa3b, v124
    v_mul_f32 v126, 0x3fb8aa3b, v126
    v_mul_f32 v128, 0x3fb8aa3b, v128
    v_mul_f32 v130, 0x3fb8aa3b, v130
    v_mul_f32 v132, 0x3fb8aa3b, v132
    v_mul_f32 v134, 0x3fb8aa3b, v134
    v_exp_f32 v120, v120
    v_exp_f32 v122, v122
    v_exp_f32 v124, v124
    v_exp_f32 v126, v126
    v_exp_f32 v128, v128
    v_exp_f32 v130, v130
    v_exp_f32 v132, v132
    v_exp_f32 v134, v134
    v_mul_f32 v17, v120, v121
    v_fmac_f32 v17, v122, v123
    v_fmac_f32 v17, v124, v125
    v_fmac_f32 v17, v126, v127
    v_fmac_f32 v17, v128, v129
    v_fmac_f32 v17, v130, v131
    v_fmac_f32 v17, v132, v133
    v_fmac_f32 v17, v134, v135
    s_nop 1
    v_add_f32_dpp v17, v17, v17 quad_perm:[1,0,3,2] row_mask:0xf bank_mask:0xf
    s_nop 1
    v_add_f32_dpp v17, v17, v17 quad_perm:[2,3,0,1] row_mask:0xf bank_mask:0xf
    s_nop 1
    v_add_f32_dpp v17, v17, v17 row_half_mirror row_mask:0xf bank_mask:0xf
    v_min_u32 v16, -2, v16
    v_min_u32 v17, -2, v17
    s_lshl_b32 s37, s47, 5
    s_add_u32 s37, s37, s48
    s_lshl_b32 s37, s37, 1
    s_and_b32 s38, s2, 1
    s_add_u32 s37, s37, s38
    s_lshl_b32 s37, s37, 7
    s_add_u32 s37, s37, 0xa0000
    s_mov_b32 exec_lo, 0x01010101
    s_mov_b32 exec_hi, 0x01010101
    buffer_store_dwordx2 v[16:17], v2, s[12:15], s37 offen sc1
    s_mov_b64 exec, -1
    s_lshl_b32 s38, s47, 13
    s_add_u32 s38, s38, 0xa0000
    s_add_u32 s39, s38, 4096
    s_mov_b32 s59, 0
L_sp_111:
    ds_read_b32 v3, v7 offset:28
    s_waitcnt lgkmcnt(0)
    v_cmp_gt_u32 vcc, 9, v3
    s_cbranch_vccz L_spx_112
    s_sleep 4
    s_add_u32 s59, s59, 1
    s_cmp_lt_u32 s59, 0x800000
    s_cbranch_scc1 L_sp_111
L_spx_112:
    s_mov_b32 s59, 0
L_sp_113:
    ds_read_b32 v3, v7 offset:44
    s_waitcnt lgkmcnt(0)
    v_cmp_gt_u32 vcc, 1, v3
    s_cbranch_vccz L_spx_114
    s_sleep 1
    s_add_u32 s59, s59, 1
    s_cmp_lt_u32 s59, 0x800000
    s_cbranch_scc1 L_sp_113
L_spx_114:
    s_mov_b32 s59, 0
L_g_115:
    buffer_load_dwordx4 v[120:123], v154, s[12:15], s38 offen offset:0 sc1
    buffer_load_dwordx4 v[124:127], v154, s[12:15], s38 offen offset:2048 sc1
    buffer_load_dwordx4 v[128:131], v154, s[12:15], s39 offen offset:0 sc1
    buffer_load_dwordx4 v[132:135], v154, s[12:15], s39 offen offset:2048 sc1
    s_waitcnt vmcnt(0)
    v_max_u32 v16, v120, v121
    v_max3_u32 v16, v16, v122, v123
    v_max3_u32 v16, v16, v124, v125
    v_max3_u32 v16, v16, v126, v127
    v_max3_u32 v16, v16, v128, v129
    v_max3_u32 v16, v16, v130, v131
    v_max3_u32 v16, v16, v132, v133
    v_max3_u32 v16, v16, v134, v135
    v_cmp_eq_u32 vcc, -1, v16
    s_cbranch_vccz L_gx_116
    s_sleep 8
    s_add_u32 s59, s59, 1
    s_cmp_lt_u32 s59, 0x100000
    s_cbranch_scc1 L_g_115
L_gx_116:
    v_max3_f32 v16, v120, v124, v128
    v_max_f32 v16, v16, v132
    s_nop 1
    v_max_f32_dpp v16, v16, v16 row_ror:4 row_mask:0xf bank_mask:0xf
    s_nop 1
    v_max_f32_dpp v16, v16, v16 row_ror:8 row_mask:0xf bank_mask:0xf
    v_mov_b32 v20, v16
    s_nop 1
    v_permlane16_swap_b32 v16, v20
    v_max_f32 v16, v16, v20
    v_mov_b32 v20, v16
    s_nop 1
    v_permlane32_swap_b32 v16, v20
    v_max_f32 v16, v16, v20
    v_sub_f32 v120, v120, v16
    v_sub_f32 v124, v124, v16
    v_sub_f32 v128, v128, v16
    v_sub_f32 v132, v132, v16
    v_mul_f32 v120, 0x3fb8aa3b, v120
    v_mul_f32 v124, 0x3fb8aa3b, v124
    v_mul_f32 v128, 0x3fb8aa3b, v128
    v_mul_f32 v132, 0x3fb8aa3b, v132
    v_exp_f32 v120, v120
    v_exp_f32 v124, v124
    v_exp_f32 v128, v128
    v_exp_f32 v132, v132
    v_mul_f32 v21, v120, v121
    v_fmac_f32 v21, v124, v125
    v_fmac_f32 v21, v128, v129
    v_fmac_f32 v21, v132, v133
    s_nop 1
    v_add_f32_dpp v21, v21, v21 row_ror:4 row_mask:0xf bank_mask:0xf
    s_nop 1
    v_add_f32_dpp v21, v21, v21 row_ror:8 row_mask:0xf bank_mask:0xf
    v_mov_b32 v20, v21
    s_nop 1
    v_permlane16_swap_b32 v21, v20
    v_add_f32 v21, v21, v20
    v_mov_b32 v20, v21
    s_nop 1
    v_permlane32_swap_b32 v21, v20
    v_add_f32 v21, v21, v20
    v_rcp_f32 v22, v21
    s_nop 0
    v_fma_f32 v23, -v21, v22, 1.0
    v_fma_f32 v17, v23, v22, v22
    v_max3_f32 v18, v122, v126, v130
    v_max_f32 v18, v18, v134
    s_nop 1
    v_max_f32_dpp v18, v18, v18 row_ror:4 row_mask:0xf bank_mask:0xf
    s_nop 1
    v_max_f32_dpp v18, v18, v18 row_ror:8 row_mask:0xf bank_mask:0xf
    v_mov_b32 v20, v18
    s_nop 1
    v_permlane16_swap_b32 v18, v20
    v_max_f32 v18, v18, v20
    v_mov_b32 v20, v18
    s_nop 1
    v_permlane32_swap_b32 v18, v20
    v_max_f32 v18, v18, v20
    v_sub_f32 v122, v122, v18
    v_sub_f32 v126, v126, v18
    v_sub_f32 v130, v130, v18
    v_sub_f32 v134, v134, v18
    v_mul_f32 v122, 0x3fb8aa3b, v122
    v_mul_f32 v126, 0x3fb8aa3b, v126
    v_mul_f32 v130, 0x3fb8aa3b, v130
    v_mul_f32 v134, 0x3fb8aa3b, v134
    v_exp_f32 v122, v122
    v_exp_f32 v126, v126
    v_exp_f32 v130, v130
    v_exp_f32 v134, v134
    v_mul_f32 v21, v122, v123
    v_fmac_f32 v21, v126, v127
    v_fmac_f32 v21, v130, v131
    v_fmac_f32 v21, v134, v135
    s_nop 1
    v_add_f32_dpp v21, v21, v21 row_ror:4 row_mask:0xf bank_mask:0xf
    s_nop 1
    v_add_f32_dpp v21, v21, v21 row_ror:8 row_mask:0xf bank_mask:0xf
    v_mov_b32 v20, v21
    s_nop 1
    v_permlane16_swap_b32 v21, v20
    v_add_f32 v21, v21, v20
    v_mov_b32 v20, v21
    s_nop 1
    v_permlane32_swap_b32 v21, v20
    v_add_f32 v21, v21, v20
    v_rcp_f32 v22, v21
    s_nop 0
    v_fma_f32 v23, -v21, v22, 1.0
    v_fma_f32 v19, v23, v22, v22
    s_mov_b64 exec, 15
    ds_write_b128 v4, v[16:19] offset:64
    s_mov_b64 exec, -1
    v_mov_b32 v3, 1
    s_mov_b64 exec, 1
    ds_add_u32 v7, v3 offset:8
    s_mov_b64 exec, -1
L_vdone:
    s_cmp_lt_u32 s2, 224
    s_cbranch_scc1 L_not5
    s_mov_b32 s59, 0
L_sp_117:
    ds_read_b32 v3, v7 offset:60
    s_waitcnt lgkmcnt(0)
    v_cmp_gt_u32 vcc, 712, v3
    s_cbranch_vccz L_spx_118
    s_sleep 2
    s_add_u32 s59, s59, 1
    s_cmp_lt_u32 s59, 0x800000
    s_cbranch_scc1 L_sp_117
L_spx_118:
    buffer_load_dwordx4 v[72:75], v4, s[12:15], s54 offen offset:0 sc1
    buffer_load_dwordx4 v[76:79], v4, s[12:15], s54 offen offset:1024 sc1
    buffer_load_dwordx4 v[80:83], v4, s[12:15], s54 offen offset:2048 sc1
    buffer_load_dwordx4 v[84:87], v4, s[12:15], s54 offen offset:3072 sc1
    buffer_load_dwordx4 v[88:91], v4, s[12:15], s22 offen offset:0 sc1
    buffer_load_dwordx4 v[92:95], v4, s[12:15], s22 offen offset:1024 sc1
    buffer_load_dwordx4 v[96:99], v4, s[12:15], s22 offen offset:2048 sc1
    buffer_load_dwordx4 v[100:103], v4, s[12:15], s22 offen offset:3072 sc1
    buffer_load_dwordx4 v[40:43], v4, s[12:15], s16 offen offset:0 sc1
    buffer_load_dwordx4 v[44:47], v4, s[12:15], s16 offen offset:1024 sc1
    buffer_load_dwordx4 v[48:51], v4, s[12:15], s16 offen offset:2048 sc1
    buffer_load_dwordx4 v[52:55], v4, s[12:15], s16 offen offset:3072 sc1
L_not5:
    s_mov_b32 s59, 0
L_sp_119:
    ds_read_b32 v3, v7 offset:24
    s_waitcnt lgkmcnt(0)
    v_cmp_gt_u32 vcc, 1, v3
    s_cbranch_vccz L_spx_120
    s_sleep 4
    s_add_u32 s59, s59, 1
    s_cmp_lt_u32 s59, 0x800000
    s_cbranch_scc1 L_sp_119
L_spx_120:
    ds_read_b32 v3, v7 offset:44
    s_waitcnt lgkmcnt(0)
    v_readfirstlane_b32 s10, v3
    s_nop 0
    s_and_b32 s37, s10, 4
    s_lshl_b32 s37, s37, 11
    s_add_u32 s36, s36, s37
    s_add_u32 s17, s17, s37
    s_add_u32 s18, s18, s37
    s_add_u32 s19, s19, s37
    s_add_u32 s20, s20, s37
    s_mov_b32 s59, 0
L_sp_121:
    ds_read_b32 v3, v7 offset:24
    s_waitcnt lgkmcnt(0)
    v_cmp_gt_u32 vcc, 4, v3
    s_cbranch_vccz L_spx_122
    s_add_u32 s59, s59, 1
    s_cmp_lt_u32 s59, 0x800000
    s_cbranch_scc1 L_sp_121
L_spx_122:
    ds_read_b128 v[120:123], v158 offset:12288
    ds_read_b128 v[124:127], v158 offset:16640
    ds_read_b128 v[128:131], v158 offset:20992
    ds_read_b128 v[132:135], v158 offset:25344
    s_waitcnt lgkmcnt(0)
    v_pk_add_f32 v[120:121], v[120:121], v[124:125]
    v_pk_add_f32 v[122:123], v[122:123], v[126:127]
    v_pk_add_f32 v[128:129], v[128:129], v[132:133]
    v_pk_add_f32 v[130:131], v[130:131], v[134:135]
    v_pk_add_f32 v[120:121], v[120:121], v[128:129]
    v_pk_add_f32 v[122:123], v[122:123], v[130:131]
    s_mov_b32 s59, 0
L_sp_123:
    ds_read_b32 v3, v7 offset:56
    s_waitcnt lgkmcnt(0)
    v_cmp_gt_u32 vcc, 3, v3
    s_cbranch_vccz L_spx_124
    s_add_u32 s59, s59, 1
    s_cmp_lt_u32 s59, 0x800000
    s_cbranch_scc1 L_sp_123
L_spx_124:
    s_mov_b32 s59, 0x800000
L_opf:
    ds_read_b32 v3, v7 offset:56
    ds_read_b128 v[136:139], v158 offset:29696
    ds_read_b128 v[140:143], v158 offset:34048
    ds_read_b128 v[144:147], v158 offset:38400
    ds_read_b128 v[148:151], v158 offset:42752
    s_waitcnt lgkmcnt(4)
    v_cmp_gt_u32 vcc, 4, v3
    s_sub_u32 s59, s59, 1
    s_cbranch_vccz L_opx
    s_cbranch_scc0 L_opf
L_opx:
    s_waitcnt lgkmcnt(0)
    v_pk_add_f32 v[136:137], v[136:137], v[140:141]
    v_pk_add_f32 v[138:139], v[138:139], v[142:143]
    v_pk_add_f32 v[144:145], v[144:145], v[148:149]
    v_pk_add_f32 v[146:147], v[146:147], v[150:151]
    v_pk_add_f32 v[124:125], v[136:137], v[144:145]
    v_pk_add_f32 v[126:127], v[138:139], v[146:147]
    v_pk_add_f32 v[16:17], v[120:121], v[124:125]
    v_pk_add_f32 v[18:19], v[122:123], v[126:127]
    v_bfi_b32 v16, 15, s8, v16
    v_bfi_b32 v19, 15, s9, v19
    s_bitcmp0_b32 s10, 1
    s_cbranch_scc1 L_ps_125
    buffer_store_dwordx4 v[16:19], v159, s[12:15], s53 offen
L_pb_126:
    v_mov_b32 v3, 1
    s_mov_b64 exec, 1
    ds_add_u32 v7, v3 offset:40
    s_mov_b64 exec, -1
    s_cmp_ge_u32 s2, 224
    s_cbranch_scc1 L_reducer
    s_bitcmp1_b32 s2, 3
    s_cbranch_scc1 L_noyc
    s_cmp_lg_u32 s3, 3
    s_cbranch_scc1 L_noyc
    s_lshr_b32 s38, s2, 4
    s_mul_i32 s38, s38, 1176
    s_lshr_b32 s38, s38, 10
    s_lshl_b32 s38, s38, 8
    s_add_u32 s38, s38, s36
    s_add_u32 s38, s38, 0x1000
    s_mov_b32 s59, 0
L_sp_127:
    ds_read_b32 v3, v7 offset:32
    s_waitcnt lgkmcnt(0)
    v_cmp_gt_u32 vcc, 8, v3
    s_cbranch_vccz L_spx_128
    s_sleep 2
    s_add_u32 s59, s59, 1
    s_cmp_lt_u32 s59, 0x800000
    s_cbranch_scc1 L_sp_127
L_spx_128:
    s_mov_b32 s59, 0x400000
L_pl_129:
    buffer_load_dwordx2 v[40:41], v164, s[12:15], s38 offen sc1
    s_waitcnt vmcnt(0)
    v_max_u32 v20, v40, v41
    v_cmp_eq_u32 vcc, -1, v20
    s_sub_u32 s59, s59, 1
    s_cbranch_vccz L_plx_130
    s_cbranch_scc0 L_pl_129
L_plx_130:
    ds_write_b64 v164, v[40:41] offset:1536
    s_branch L_cdone
L_noyc:
    s_bitcmp0_b32 s2, 3
    s_cbranch_scc1 L_nooc
    s_cmp_lg_u32 s3, 3
    s_cbranch_scc1 L_nooc
    s_lshr_b32 s38, s2, 4
    s_lshl_b32 s38, s38, 11
    s_add_u32 s38, s38, 0xb0000
    s_lshr_b32 s37, s2, 6
    s_lshl_b32 s37, s37, 13
    s_add_u32 s38, s38, s37
    s_bfe_u32 s37, s10, 0x10002
    s_lshl_b32 s37, s37, 13
    s_add_u32 s38, s38, s37
    v_mov_b32 v40, -1
    v_mov_b32 v44, -1
    s_mov_b32 s59, 0x400000
L_pl_131:
    buffer_load_dwordx4 v[40:43], v29, s[12:15], s38 offen offset:0 sc1
    buffer_load_dwordx4 v[44:47], v29, s[12:15], s38 offen offset:128 sc1
    s_waitcnt vmcnt(0)
    v_max_u32 v20, v40, v41
    v_max3_u32 v20, v20, v42, v43
    v_max3_u32 v20, v20, v44, v45
    v_max3_u32 v20, v20, v46, v47
    v_cmp_eq_u32 vcc, -1, v20
    s_sub_u32 s59, s59, 1
    s_cbranch_vccz L_plx_132
    s_cbranch_scc0 L_pl_131
L_plx_132:
    v_pk_add_f32 v[48:49], v[40:41], v[44:45]
    v_pk_add_f32 v[50:51], v[42:43], v[46:47]
    v_cvt_pk_bf16_f32 v52, v48, v49
    v_cvt_pk_bf16_f32 v53, v50, v51
    v_min_u32 v52, -2, v52
    v_min_u32 v53, -2, v53
    ds_write_b64 v164, v[52:53] offset:1024
    s_branch L_cdone
L_nooc:
    s_bfe_u32 s37, s2, 0x10003
    s_add_u32 s37, s37, s3
    s_cmp_lg_u32 s37, 2
    s_cbranch_scc1 L_cdone
    s_cmp_eq_u32 s3, 1
    s_cbranch_scc1 L_egather
    s_mov_b32 s59, 0
L_sp_133:
    ds_read_b32 v3, v7 offset:32
    s_waitcnt lgkmcnt(0)
    v_cmp_gt_u32 vcc, 8, v3
    s_cbranch_vccz L_spx_134
    s_sleep 1
    s_add_u32 s59, s59, 1
    s_cmp_lt_u32 s59, 0x800000
    s_cbranch_scc1 L_sp_133
L_spx_134:
    s_mov_b32 s59, 0x400000
L_pl_135:
    buffer_load_dwordx2 v[16:17], v30, s[12:15], s36 offen sc1
    s_waitcnt vmcnt(0)
    v_max_u32 v20, v16, v17
    v_cmp_eq_u32 vcc, -1, v20
    s_sub_u32 s59, s59, 1
    s_cbranch_vccz L_plx_136
    s_cbranch_scc0 L_pl_135
L_plx_136:
    s_mov_b32 s40, 0
    v_permlane32_swap_b32 v16, v17
    v_add_f32 v16, v16, v17
    v_mov_b32 v17, v16
    s_nop 1
    v_permlane16_swap_b32 v16, v17
    v_add_f32 v16, v16, v17
    s_nop 1
    v_add_f32_dpp v16, v16, v16 row_ror:8 row_mask:0xf bank_mask:0xf
    s_nop 1
    v_add_f32_dpp v16, v16, v16 row_ror:4 row_mask:0xf bank_mask:0xf
    s_nop 1
    v_add_f32_dpp v16, v16, v16 row_ror:2 row_mask:0xf bank_mask:0xf
    s_nop 1
    v_add_f32_dpp v16, v16, v16 row_ror:1 row_mask:0xf bank_mask:0xf
    v_mul_f32 v16, 0x3a800000, v16
    s_nop 0
    v_readlane_b32 s42, v16, 0
    v_readlane_b32 s43, v16, 32
    s_nop 0
    v_mov_b32 v17, s42
    v_add_f32 v16, s40, v17
    v_fma_f32 v17, -v17, v17, s43
    v_max_f32 v17, 0, v17
    v_cvt_pk_bf16_f32 v16, v16, v17
    v_and_b32 v17, 0xffff0000, v16
    v_lshlrev_b32 v16, 16, v16
    v_add_f32 v17, 0x3727c5ac, v17
    v_cvt_pk_bf16_f32 v17, v17, v17
    v_lshlrev_b32 v17, 16, v17
    v_sqrt_f32 v17, v17
    s_nop 0
    v_cvt_pk_bf16_f32 v17, v17, v17
    v_lshlrev_b32 v17, 16, v17
    v_rcp_f32 v17, v17
    s_nop 0
    v_mul_f32 v16, v16, v17
    v_xor_b32 v18, 0x80000000, v16
    v_min_u32 v17, -2, v17
    v_min_u32 v18, -2, v18
    v_mov_b32 v16, v17
    v_mov_b32 v19, 1.0
    ds_write_b128 v7, v[16:19] offset:1024
    s_branch L_cdone
L_egather:
    s_lshr_b32 s38, s51, 1
    s_lshl_b32 s38, s38, 12
    s_and_b32 s37, s2, 7
    s_lshl_b32 s37, s37, 13
    s_add_u32 s38, s38, s37
    s_xor_b32 s56, s56, 0x88888888
    s_add_u32 s38, s38, 0x200000
    s_mov_b32 s59, 0
L_sp_137:
    ds_read_b32 v3, v7 offset:32
    s_waitcnt lgkmcnt(0)
    v_cmp_gt_u32 vcc, 8, v3
    s_cbranch_vccz L_spx_138
    s_sleep 2
    s_add_u32 s59, s59, 1
    s_cmp_lt_u32 s59, 0x800000
    s_cbranch_scc1 L_sp_137
L_spx_138:
    s_mov_b32 s59, 0x400000
L_pl_139:
    buffer_load_dwordx4 v[120:123], v4, s[12:15], s38 offen offset:0 sc1
    buffer_load_dwordx4 v[124:127], v4, s[12:15], s38 offen offset:1024 sc1
    buffer_load_dwordx4 v[128:131], v4, s[12:15], s38 offen offset:2048 sc1
    buffer_load_dwordx4 v[132:135], v4, s[12:15], s38 offen offset:3072 sc1
    s_waitcnt vmcnt(0)
    v_lshlrev_b32 v20, 28, v120
    v_alignbit_b32 v20, v123, v20, 4
    v_alignbit_b32 v20, v124, v20, 4
    v_alignbit_b32 v20, v127, v20, 4
    v_alignbit_b32 v20, v128, v20, 4
    v_alignbit_b32 v20, v131, v20, 4
    v_alignbit_b32 v20, v132, v20, 4
    v_alignbit_b32 v20, v135, v20, 4
    v_cmp_ne_u32 vcc, s56, v20
    s_sub_u32 s59, s59, 1
    s_cbranch_vccz L_plx_140
    s_cbranch_scc0 L_pl_139
L_plx_140:
L_egot:
    v_and_b32 v136, -16, v120
    v_and_b32 v140, -16, v124
    v_and_b32 v139, -16, v123
    v_and_b32 v141, -16, v127
    v_add_f32 v137, v121, v125
    v_add_f32 v138, v122, v126
    v_add_f32 v136, v136, v140
    v_add_f32 v139, v139, v141
    v_and_b32 v144, -16, v128
    v_and_b32 v148, -16, v132
    v_and_b32 v147, -16, v131
    v_and_b32 v149, -16, v135
    v_add_f32 v145, v129, v133
    v_add_f32 v146, v130, v134
    v_add_f32 v144, v144, v148
    v_add_f32 v147, v147, v149
    v_pk_add_f32 v[136:137], v[136:137], v[144:145]
    v_pk_add_f32 v[138:139], v[138:139], v[146:147]
    s_nop 1
    v_permlane32_swap_b32 v136, v138
    v_permlane32_swap_b32 v137, v139
    v_add_f32 v136, v136, v138
    v_add_f32 v137, v137, v139
    s_nop 1
    v_permlane16_swap_b32 v136, v137
    v_add_f32 v136, v136, v137
    v_cvt_pk_bf16_f32 v16, v136, v136
    v_lshlrev_b32 v16, 16, v16
    s_nop 1
    v_mov_b32_dpp v17, v16 row_ror:8 row_mask:0xf bank_mask:0xf
    v_mul_f32 v19, 0xbfb8aa3b, v16
    v_exp_f32 v19, v19
    v_max_f32 v18, 0xc3000000, v16
    v_add_f32 v19, 1.0, v19
    v_min_f32 v19, 0x7e800000, v19
    v_rcp_f32 v20, v19
    s_nop 0
    v_mul_f32 v21, v18, v20
    v_fma_f32 v19, -v21, v19, v18
    v_fma_f32 v18, v19, v20, v21
    v_cvt_pk_bf16_f32 v18, v18, v18
    v_lshlrev_b32 v18, 16, v18
    v_mul_f32 v18, v18, v17
    v_mov_b32 v19, v18
    s_nop 1
    v_permlane16_swap_b32 v18, v19
    v_cvt_pk_bf16_f32 v18, v18, v19
    v_min_u32 v18, -2, v18
    ds_write_b32 v166, v18 offset:1536
    s_branch L_cdone
L_reducer:
    v_not_b32 v120, s8
    v_not_b32 v124, s8
    v_not_b32 v128, s8
    v_not_b32 v132, s8
    v_not_b32 v136, s8
    v_not_b32 v140, s8
    v_not_b32 v144, s8
    v_not_b32 v148, s8
    v_not_b32 v40, s8
    v_not_b32 v44, s8
    v_not_b32 v48, s8
    v_not_b32 v52, s8
    s_mov_b32 s38, 15
    s_lshl_b32 s39, s56, 16
    s_mov_b32 s59, 0x400000
L_ag:
    s_bitcmp0_b32 s38, 0
    s_cbranch_scc1 L_agi0
    buffer_load_dwordx4 v[120:123], v4, s[12:15], s54 offen offset:0 sc1
    buffer_load_dwordx4 v[136:139], v4, s[12:15], s22 offen offset:0 sc1
L_agi0:
    s_bitcmp0_b32 s38, 1
    s_cbranch_scc1 L_agi1
    buffer_load_dwordx4 v[124:127], v4, s[12:15], s54 offen offset:1024 sc1
    buffer_load_dwordx4 v[140:143], v4, s[12:15], s22 offen offset:1024 sc1
L_agi1:
    s_bitcmp0_b32 s38, 2
    s_cbranch_scc1 L_agi2
    buffer_load_dwordx4 v[128:131], v4, s[12:15], s54 offen offset:2048 sc1
    buffer_load_dwordx4 v[144:147], v4, s[12:15], s22 offen offset:2048 sc1
L_agi2:
    s_bitcmp0_b32 s38, 3
    s_cbranch_scc1 L_agi3
    buffer_load_dwordx4 v[132:135], v4, s[12:15], s54 offen offset:3072 sc1
    buffer_load_dwordx4 v[148:151], v4, s[12:15], s22 offen offset:3072 sc1
L_agi3:
    s_waitcnt vmcnt(0)
    s_bitcmp0_b32 s38, 0
    s_cbranch_scc1 L_agc0
    v_lshlrev_b32 v20, 28, v120
    v_alignbit_b32 v20, v123, v20, 4
    v_alignbit_b32 v20, v136, v20, 4
    v_alignbit_b32 v20, v139, v20, 4
    v_cmp_ne_u32 vcc, s39, v20
    v_and_b32 v120, -16, v120
    v_and_b32 v123, -16, v123
    v_and_b32 v136, -16, v136
    v_and_b32 v139, -16, v139
    s_cbranch_vccnz L_agc0
    s_bitset0_b32 s38, 0
L_agc0:
    s_bitcmp0_b32 s38, 1
    s_cbranch_scc1 L_agc1
    v_lshlrev_b32 v20, 28, v124
    v_alignbit_b32 v20, v127, v20, 4
    v_alignbit_b32 v20, v140, v20, 4
    v_alignbit_b32 v20, v143, v20, 4
    v_cmp_ne_u32 vcc, s39, v20
    v_and_b32 v124, -16, v124
    v_and_b32 v127, -16, v127
    v_and_b32 v140, -16, v140
    v_and_b32 v143, -16, v143
    s_cbranch_vccnz L_agc1
    s_bitset0_b32 s38, 1
L_agc1:
    s_bitcmp0_b32 s38, 2
    s_cbranch_scc1 L_agc2
    v_lshlrev_b32 v20, 28, v128
    v_alignbit_b32 v20, v131, v20, 4
    v_alignbit_b32 v20, v144, v20, 4
    v_alignbit_b32 v20, v147, v20, 4
    v_cmp_ne_u32 vcc, s39, v20
    v_and_b32 v128, -16, v128
    v_and_b32 v131, -16, v131
    v_and_b32 v144, -16, v144
    v_and_b32 v147, -16, v147
    s_cbranch_vccnz L_agc2
    s_bitset0_b32 s38, 2
L_agc2:
    s_bitcmp0_b32 s38, 3
    s_cbranch_scc1 L_agc3
    v_lshlrev_b32 v20, 28, v132
    v_alignbit_b32 v20, v135, v20, 4
    v_alignbit_b32 v20, v148, v20, 4
    v_alignbit_b32 v20, v151, v20, 4
    v_cmp_ne_u32 vcc, s39, v20
    v_and_b32 v132, -16, v132
    v_and_b32 v135, -16, v135
    v_and_b32 v148, -16, v148
    v_and_b32 v151, -16, v151
    s_cbranch_vccnz L_agc3
    s_bitset0_b32 s38, 3
L_agc3:
    s_cmp_eq_u32 s38, 0
    s_cbranch_scc1 L_agx
    s_sub_u32 s59, s59, 1
    s_cbranch_scc0 L_ag
L_agx:
    v_pk_add_f32 v[120:121], v[120:121], v[124:125]
    v_pk_add_f32 v[122:123], v[122:123], v[126:127]
    v_pk_add_f32 v[128:129], v[128:129], v[132:133]
    v_pk_add_f32 v[130:131], v[130:131], v[134:135]
    v_pk_add_f32 v[72:73], v[120:121], v[128:129]
    v_pk_add_f32 v[74:75], v[122:123], v[130:131]
    v_pk_add_f32 v[136:137], v[136:137], v[140:141]
    v_pk_add_f32 v[138:139], v[138:139], v[142:143]
    v_pk_add_f32 v[144:145], v[144:145], v[148:149]
    v_pk_add_f32 v[146:147], v[146:147], v[150:151]
    v_pk_add_f32 v[88:89], v[136:137], v[144:145]
    v_pk_add_f32 v[90:91], v[138:139], v[146:147]
    v_permlane32_swap_b32 v72, v74
    v_permlane32_swap_b32 v73, v75
    v_permlane32_swap_b32 v88, v90
    v_permlane32_swap_b32 v89, v91
    v_add_f32 v72, v72, v74
    v_add_f32 v73, v73, v75
    v_add_f32 v88, v88, v90
    v_add_f32 v89, v89, v91
    v_permlane16_swap_b32 v72, v73
    s_nop 0
    v_permlane16_swap_b32 v88, v89
    v_add_f32 v72, v72, v73
    v_add_f32 v88, v88, v89
    s_nop 0
    v_add_f32_dpp v16, v72, v72 row_ror:8 row_mask:0xf bank_mask:0x3
    s_nop 1
    v_add_f32_dpp v16, v88, v88 row_ror:8 row_mask:0xf bank_mask:0xc
    v_min_u32 v16, -2, v16
    ds_write_b32 v163, v16 offset:3072
    v_mov_b32 v3, 1
    s_mov_b64 exec, 1
    ds_add_rtn_u32 v3, v7, v3 offset:12
    s_mov_b64 exec, -1
    ds_read_b128 v[16:19], v4 offset:3072
    s_waitcnt lgkmcnt(0)
    v_readfirstlane_b32 s37, v3
    s_nop 0
    s_cmp_lg_u32 s37, 7
    s_cbranch_scc1 L_l4_141
    buffer_store_dwordx4 v[16:19], v29, s[12:15], s50 offen sc1
    s_add_u32 s50, s50, 0x2000
    buffer_store_dwordx4 v[16:19], v29, s[12:15], s50 offen sc1
L_l4_141:
    s_mov_b32 s59, 0x400000
L_pl_142:
    buffer_load_dwordx4 v[40:43], v4, s[12:15], s16 offen offset:0 sc1
    buffer_load_dwordx4 v[44:47], v4, s[12:15], s16 offen offset:1024 sc1
    buffer_load_dwordx4 v[48:51], v4, s[12:15], s16 offen offset:2048 sc1
    buffer_load_dwordx4 v[52:55], v4, s[12:15], s16 offen offset:3072 sc1
    s_waitcnt vmcnt(0)
    v_lshlrev_b32 v20, 28, v40
    v_alignbit_b32 v20, v43, v20, 4
    v_alignbit_b32 v20, v44, v20, 4
    v_alignbit_b32 v20, v47, v20, 4
    v_alignbit_b32 v20, v48, v20, 4
    v_alignbit_b32 v20, v51, v20, 4
    v_alignbit_b32 v20, v52, v20, 4
    v_alignbit_b32 v20, v55, v20, 4
    v_cmp_ne_u32 vcc, s56, v20
    s_sub_u32 s59, s59, 1
    s_cbranch_vccz L_plx_143
    s_cbranch_scc0 L_pl_142
L_plx_143:
    v_and_b32 v104, -16, v40
    v_and_b32 v108, -16, v44
    v_and_b32 v107, -16, v43
    v_and_b32 v109, -16, v47
    v_add_f32 v105, v41, v45
    v_add_f32 v106, v42, v46
    v_add_f32 v104, v104, v108
    v_add_f32 v107, v107, v109
    v_and_b32 v112, -16, v48
    v_and_b32 v116, -16, v52
    v_and_b32 v115, -16, v51
    v_and_b32 v117, -16, v55
    v_add_f32 v113, v49, v53
    v_add_f32 v114, v50, v54
    v_add_f32 v112, v112, v116
    v_add_f32 v115, v115, v117
    v_pk_add_f32 v[104:105], v[104:105], v[112:113]
    v_pk_add_f32 v[106:107], v[106:107], v[114:115]
    s_nop 1
    v_permlane32_swap_b32 v104, v106
    v_permlane32_swap_b32 v105, v107
    v_add_f32 v104, v104, v106
    v_add_f32 v105, v105, v107
    s_nop 1
    v_permlane16_swap_b32 v104, v105
    v_add_f32 v104, v104, v105
    s_nop 1
    v_add_f32_dpp v16, v104, v104 row_ror:8 row_mask:0xf bank_mask:0xf
    ds_write_b32 v160, v16 offset:4096
    v_mov_b32 v3, 1
    s_mov_b64 exec, 1
    ds_add_rtn_u32 v3, v7, v3 offset:16
    s_mov_b64 exec, -1
    ds_read_b32 v16, v162 offset:4096
    ds_read_b32 v17, v162 offset:4224
    ds_read_b32 v18, v162 offset:4352
    ds_read_b32 v19, v162 offset:4480
    s_waitcnt lgkmcnt(0)
    v_readfirstlane_b32 s37, v3
    s_nop 0
    s_cmp_lg_u32 s37, 7
    s_cbranch_scc1 L_bwait
    v_add_f32 v16, v16, v17
    v_add_f32 v18, v18, v19
    v_add_f32 v16, v16, v18
    v_cvt_pk_bf16_f32 v16, v16, v16
    v_lshlrev_b32 v16, 16, v16
    v_mul_f32 v16, v16, v155
    v_cvt_pk_bf16_f32 v16, v16, v16
    v_lshlrev_b32 v16, 16, v16
    v_add_f32 v16, v16, v167
    v_mov_b32 v17, v16
    v_mov_b32 v22, v16
    s_nop 0
    v_permlane16_swap_b32 v16, v17
    v_cvt_pk_bf16_f32 v17, v16, v17
    v_lshlrev_b32 v18, 16, v17
    v_and_b32 v19, 0xffff0000, v17
    v_mul_f32 v23, v18, v18
    v_add_f32 v17, v18, v19
    v_fmac_f32 v23, v19, v19
    v_pk_mul_f32 v[18:19], v[18:19], v[32:33]
    v_cvt_pk_bf16_f32 v16, v18, v19
    v_mov_b32_dpp v17, v23 quad_perm:[0,1,2,3] row_mask:0xa bank_mask:0xf
    v_lshlrev_b32 v20, 16, v16
    v_and_b32 v21, 0xffff0000, v16
    v_add_f32_dpp v17, v17, v17 quad_perm:[1,0,3,2] row_mask:0xf bank_mask:0xf
    v_pk_add_f32 v[18:19], v[18:19], v[20:21] neg_lo:[0,1] neg_hi:[0,1]
    v_cvt_pk_bf16_f32 v18, v18, v19
    v_add_f32_dpp v17, v17, v17 quad_perm:[2,3,0,1] row_mask:0xf bank_mask:0xf
    s_nop 1
    v_add_f32_dpp v17, v17, v17 row_half_mirror row_mask:0xf bank_mask:0xf
    s_nop 1
    v_mov_b32_dpp v16, v17 quad_perm:[0,1,2,3] row_mask:0xf bank_mask:0xc
    s_nop 1
    v_mov_b32_dpp v16, v18 quad_perm:[0,1,2,3] row_mask:0xa bank_mask:0x3
    v_min_u32 v16, -2, v16
    buffer_store_dword v16, v31, s[12:15], s24 offen sc1
    s_add_u32 s24, s24, 0x2000
    buffer_store_dword v16, v31, s[12:15], s24 offen sc1
    v_mov_b32 v3, 1
    s_mov_b64 exec, 1
    ds_add_u32 v7, v3 offset:20
    s_mov_b64 exec, -1
    v_cvt_pk_bf16_f32 v167, v22, v22
    v_lshlrev_b32 v167, 16, v167
    s_branch L_bdone
L_bwait:
    s_mov_b32 s59, 0
L_sp_144:
    ds_read_b32 v3, v7 offset:20
    s_waitcnt lgkmcnt(0)
    v_cmp_gt_u32 vcc, 5, v3
    s_cbranch_vccz L_spx_145
    s_sleep 1
    s_add_u32 s59, s59, 1
    s_cmp_lt_u32 s59, 0x800000
    s_cbranch_scc1 L_sp_144
L_spx_145:
    ds_read_b32 v16, v162 offset:4096
    ds_read_b32 v17, v162 offset:4224
    ds_read_b32 v18, v162 offset:4352
    ds_read_b32 v19, v162 offset:4480
    s_waitcnt lgkmcnt(0)
    v_add_f32 v16, v16, v17
    v_add_f32 v18, v18, v19
    v_add_f32 v16, v16, v18
    v_cvt_pk_bf16_f32 v16, v16, v16
    v_lshlrev_b32 v16, 16, v16
    v_mul_f32 v16, v16, v155
    v_cvt_pk_bf16_f32 v16, v16, v16
    v_lshlrev_b32 v16, 16, v16
    v_add_f32 v16, v16, v167
    v_cvt_pk_bf16_f32 v167, v16, v16
    v_lshlrev_b32 v167, 16, v167
L_bdone:
    s_lshl_b32 s43, s52, 6
    v_not_b32 v56, s8
    v_not_b32 v60, s8
    v_not_b32 v64, s8
    v_not_b32 v68, s8
    s_cmp_lt_u32 s3, 2
    s_cbranch_scc1 L_d4
    v_mov_b32 v68, s8
    v_mov_b32 v69, 0
    v_mov_b32 v70, 0
    v_mov_b32 v71, s9
    s_mov_b32 s59, 0x400000
L_pl_146:
    buffer_load_dwordx4 v[56:59], v4, s[12:15], s17 offen sc1
    buffer_load_dwordx4 v[60:63], v4, s[12:15], s18 offen sc1
    buffer_load_dwordx4 v[64:67], v4, s[12:15], s19 offen sc1
    s_waitcnt vmcnt(0)
    v_lshlrev_b32 v20, 28, v56
    v_alignbit_b32 v20, v59, v20, 4
    v_alignbit_b32 v20, v60, v20, 4
    v_alignbit_b32 v20, v63, v20, 4
    v_alignbit_b32 v20, v64, v20, 4
    v_alignbit_b32 v20, v67, v20, 4
    v_alignbit_b32 v20, v68, v20, 4
    v_alignbit_b32 v20, v71, v20, 4
    v_cmp_ne_u32 vcc, s56, v20
    s_sub_u32 s59, s59, 1
    s_cbranch_vccz L_dgot
    s_cbranch_scc0 L_pl_146
    s_branch L_dgot
L_d4:
    s_mov_b32 s59, 0x400000
L_pl_147:
    buffer_load_dwordx4 v[56:59], v4, s[12:15], s17 offen sc1
    buffer_load_dwordx4 v[60:63], v4, s[12:15], s18 offen sc1
    buffer_load_dwordx4 v[64:67], v4, s[12:15], s19 offen sc1
    buffer_load_dwordx4 v[68:71], v4, s[12:15], s20 offen sc1
    s_waitcnt vmcnt(0)
    v_lshlrev_b32 v20, 28, v56
    v_alignbit_b32 v20, v59, v20, 4
    v_alignbit_b32 v20, v60, v20, 4
    v_alignbit_b32 v20, v63, v20, 4
    v_alignbit_b32 v20, v64, v20, 4
    v_alignbit_b32 v20, v67, v20, 4
    v_alignbit_b32 v20, v68, v20, 4
    v_alignbit_b32 v20, v71, v20, 4
    v_cmp_ne_u32 vcc, s56, v20
    s_sub_u32 s59, s59, 1
    s_cbranch_vccz L_plx_148
    s_cbranch_scc0 L_pl_147
L_plx_148:
L_dgot:
    v_and_b32 v104, -16, v56
    v_and_b32 v108, -16, v60
    v_and_b32 v107, -16, v59
    v_and_b32 v109, -16, v63
    v_add_f32 v105, v57, v61
    v_add_f32 v106, v58, v62
    v_add_f32 v104, v104, v108
    v_add_f32 v107, v107, v109
    v_and_b32 v112, -16, v64
    v_and_b32 v116, -16, v68
    v_and_b32 v115, -16, v67
    v_and_b32 v117, -16, v71
    v_add_f32 v113, v65, v69
    v_add_f32 v114, v66, v70
    v_add_f32 v112, v112, v116
    v_add_f32 v115, v115, v117
    v_pk_add_f32 v[104:105], v[104:105], v[112:113]
    v_pk_add_f32 v[106:107], v[106:107], v[114:115]
    s_nop 1
    v_permlane32_swap_b32 v104, v106
    v_permlane32_swap_b32 v105, v107
    v_add_f32 v104, v104, v106
    v_add_f32 v105, v105, v107
    s_nop 1
    v_permlane16_swap_b32 v104, v105
    v_add_f32 v104, v104, v105
    s_nop 1
    v_add_f32_dpp v104, v104, v104 row_ror:8 row_mask:0xf bank_mask:0xf
    ds_write_b32 v160, v104 offset:2048
    v_mov_b32 v3, 1
    s_mov_b64 exec, 1
    ds_add_rtn_u32 v3, v7, v3 offset:52
    s_mov_b64 exec, -1
    ds_read_b32 v16, v162 offset:2048
    ds_read_b32 v17, v162 offset:2176
    ds_read_b32 v18, v162 offset:2304
    ds_read_b32 v19, v162 offset:2432
    s_waitcnt lgkmcnt(0)
    v_readfirstlane_b32 s37, v3
    s_nop 0
    s_cmp_lg_u32 s37, 3
    s_cbranch_scc1 L_nofin
    v_add_f32 v16, v16, v17
    v_add_f32 v18, v18, v19
    v_add_f32 v16, v16, v18
    v_cvt_pk_bf16_f32 v16, v16, v16
    v_lshlrev_b32 v16, 16, v16
    v_mul_f32 v16, v16, v156
    v_cvt_pk_bf16_f32 v16, v16, v16
    v_lshlrev_b32 v16, 16, v16
    v_add_f32 v16, v16, v167
    v_mov_b32 v17, v16
    s_nop 1
    v_permlane16_swap_b32 v16, v17
    v_cvt_pk_bf16_f32 v20, v16, v17
    s_mov_b32 exec_lo, 0xff
    s_mov_b32 exec_hi, 0xff
    buffer_store_dword v20, v161, s[4:7], s43 offen
    s_mov_b64 exec, -1
    s_cmp_lg_u32 s52, 0
    s_cbranch_scc1 L_nogen
    v_mov_b32 v3, s34
    s_mov_b64 exec, 1
    buffer_store_dword v3, v7, s[12:15], 0 offen
    s_mov_b64 exec, -1
L_nogen:
L_nofin:
L_cdone:
    s_waitcnt vmcnt(0)
L_end:
    s_endpgm
L_ps_63:
    buffer_store_dwordx4 v[8:11], v19, s[12:15], s44 offen sc1
    s_branch L_pb_64
L_ps_87:
    buffer_store_dwordx2 v[8:9], v20, s[12:15], s44 offen sc1
    s_branch L_pb_88
L_ps_125:
    buffer_store_dwordx4 v[16:19], v159, s[12:15], s53 offen sc1
    s_branch L_pb_126
L_codeend:
.section .rodata,"a"
.p2align 6
.amdhsa_kernel adaLN_cond__gqa_block_cached__swiglu_ffn__decode_kernel
  .amdhsa_next_free_vgpr 168
  .amdhsa_next_free_sgpr 102
  .amdhsa_accum_offset 168
  .amdhsa_group_segment_fixed_size 0
  .amdhsa_kernarg_size 112
  .amdhsa_user_sgpr_count 2
  .amdhsa_user_sgpr_kernarg_segment_ptr 1
  .amdhsa_system_sgpr_workgroup_id_x 1
  .amdhsa_float_denorm_mode_32 3
  .amdhsa_float_denorm_mode_16_64 3
.end_amdhsa_kernel
```
